```python
import torch

def _softmax(x, axis=-1):
    return torch.softmax(x, dim=axis)
def _gelu(x):
    return torch.nn.functional.gelu(x, approximate="tanh")
def _silu(x):
    return torch.nn.functional.silu(x)
def _sigmoid(x):
    return torch.sigmoid(x)
def _layernorm(x, axis=-1, eps=1e-5):
    m = x.mean(dim=axis, keepdim=True)
    v = x.var(dim=axis, keepdim=True, unbiased=False)
    return (x - m) / torch.sqrt(v + eps)
def _scatter_add(tgt, idx, src, axis=0):
    return tgt.clone().index_add_(axis, idx, src)
def _segment_sum(src, seg, n):
    out = torch.zeros((n,) + src.shape[1:], dtype=src.dtype)
    return out.index_add_(0, seg, src)
def _pad(x, pw):
    flat = tuple(v for pair in reversed(pw) for v in pair)
    return torch.nn.functional.pad(x, flat)

kernel_name = 'gated_mix__mha_block__grouped_kv_mqa__prompt'

def setup_inputs():

    _w = (lambda a: (lambda t: t.to(torch.bfloat16) if t.is_floating_point() else t)(torch.as_tensor(a)))
    def _A_setup():
        B, S, D, H = 1, 2048, 512, 32
        return {
            "x": _w((lambda *s: torch.randn(*s, dtype=torch.bfloat16) * 0.05)(B, S, D)),
            "wqkv": _w((lambda *s: torch.randn(*s, dtype=torch.bfloat16) * 3.2)(D, 3 * D)),
            "wo": _w((lambda *s: torch.randn(*s, dtype=torch.bfloat16) * 1.6)(D, D)),
        }
    _A_in = _A_setup()

    def _B_setup():
        B, S, D, H = 1, 2048, 512, 32
        Dh = D // H
        return {
            "x": _w((lambda *s: torch.randn(*s, dtype=torch.bfloat16) * 0.05)(B, S, D)),
            "wq": _w((lambda *s: torch.randn(*s, dtype=torch.bfloat16) * 3.2)(D, H * Dh)),
            "wk": _w((lambda *s: torch.randn(*s, dtype=torch.bfloat16) * 3.2)(D, Dh)),
            "wv": _w((lambda *s: torch.randn(*s, dtype=torch.bfloat16) * 1.6)(D, Dh)),
            "wo": _w((lambda *s: torch.randn(*s, dtype=torch.bfloat16) * 1.6)(H * Dh, D)),
        }
    _B_in = _B_setup()

    return {
        "A_x": _A_in["x"],
        "A_wqkv": _A_in["wqkv"],
        "A_wo": _A_in["wo"],
        "B_x": _B_in["x"],
        "B_wq": _B_in["wq"],
        "B_wk": _B_in["wk"],
        "B_wv": _B_in["wv"],
        "B_wo": _B_in["wo"],
        "gate_w": _w((lambda *s: torch.randn(*s, dtype=torch.bfloat16) * 0.05)(512) * 16.0),
    }

def reference(A_x, A_wqkv, A_wo, B_x, B_wq, B_wk, B_wv, B_wo, gate_w):
    def _A_ref(x, wqkv, wo):
        B, S, D = x.shape
        H = 32
        Dh = D // H
        qkv = (lambda x, *d: x.permute(*d))((x @ wqkv).reshape(B, S, 3, H, Dh), 2, 0, 3, 1, 4)
        q, k, v = qkv[0], qkv[1], qkv[2]
        scores = torch.einsum("bhqd,bhkd->bhqk", q, k) * (Dh ** -0.5)
        p = _softmax(scores, axis=-1)
        o = torch.einsum("bhqk,bhkd->bhqd", p, v)
        return (lambda x, *d: x.permute(*d))(o, 0, 2, 1, 3).reshape(B, S, D) @ wo

    def _B_ref(x, wq, wk, wv, wo):
        B, S, D = x.shape
        H = 32
        Dh = D // H
        q = (lambda x, *d: x.permute(*d))((x @ wq).reshape(B, S, H, Dh), 0, 2, 1, 3)
        k = x @ wk
        v = x @ wv
        scores = torch.einsum("bhqd,bkd->bhqk", q, k) * (Dh ** -0.5)
        p = _softmax(scores, axis=-1)
        o = torch.einsum("bhqk,bkd->bhqd", p, v)
        return (lambda x, *d: x.permute(*d))(o, 0, 2, 1, 3).reshape(B, S, H * Dh) @ wo

    x = A_x
    g = _sigmoid((x * gate_w).sum(-1, keepdims=True))
    a = _A_ref(x, A_wqkv, A_wo)
    b = _B_ref(x, B_wq, B_wk, B_wv, B_wo)
    return g * a + (1 - g) * b
```

```asm
; @launch grid=(256,1,1) block=(512,1,1) lds=163840
.amdgcn_target "amdgcn-amd-amdhsa--gfx950"
.text
.globl gated_mix__mha_block__grouped_kv_mqa__prompt_kernel
.p2align 8
.type gated_mix__mha_block__grouped_kv_mqa__prompt_kernel,@function
gated_mix__mha_block__grouped_kv_mqa__prompt_kernel:

    s_cmp_ge_u32 s2, 256
    s_cbranch_scc1 L_done
    s_load_dwordx4 s[32:35], s[0:1], 0
    s_load_dwordx8 s[36:43], s[0:1], 32
    s_load_dwordx4 s[44:47], s[0:1], 64
    s_load_dwordx2 s[48:49], s[0:1], 16
    s_load_dwordx2 s[50:51], s[0:1], 88
    v_lshrrev_b32 v6, 6, v0
    v_and_b32 v0, 63, v0
    v_readfirstlane_b32 s52, v6
    v_lshlrev_b32 v1, 4, v0
    v_mov_b32 v176, 0
    v_mov_b32 v177, 0
    s_and_b32 s60, s2, 7
    s_lshr_b32 s61, s2, 3
    s_lshr_b32 s53, s60, 1
    s_lshl_b32 s53, s53, 3
    s_and_b32 s62, s61, 7
    s_add_u32 s53, s53, s62
    s_and_b32 s54, s60, 1
    s_lshl_b32 s54, s54, 2
    s_lshr_b32 s63, s61, 3
    s_add_u32 s54, s54, s63
    s_lshl_b32 s3, s63, 1
    s_add_u32 s3, s3, s62
    s_and_b32 s3, s3, 6
    s_and_b32 s77, s52, 3
    s_lshr_b32 s76, s52, 2
    s_mov_b32 s68, 0xffff
    s_mov_b32 s69, 0xffff
    s_mov_b32 s67, 0x3eb8aa3b
    s_mov_b32 s6, 0
    s_waitcnt lgkmcnt(0)
    s_add_u32 s4, s50, 13631488
    s_addc_u32 s5, s51, 0
    s_load_dword s55, s[4:5], 0
    s_mov_b32 s8, s32
    s_mov_b32 s9, s33
    s_mov_b32 s10, 2097152
    s_mov_b32 s11, 0x00020000
    s_cmp_eq_u32 s52, 4
    s_cbranch_scc1 L_w4
    s_mov_b32 s28, s50
    s_mov_b32 s29, s51
    s_mov_b32 s30, 16777216
    s_mov_b32 s31, 0x00020000
    s_mov_b32 s12, s34
    s_mov_b32 s13, s35
    s_mov_b32 s14, 1572864
    s_mov_b32 s15, 0x00020000
    s_mov_b32 s16, s36
    s_mov_b32 s17, s37
    s_mov_b32 s18, 524288
    s_mov_b32 s19, 0x00020000
    s_cmp_lt_u32 s52, 2
    s_cbranch_scc1 L_g0
    s_cmp_lt_u32 s52, 4
    s_cbranch_scc1 L_g1
    s_cmp_eq_u32 s52, 5
    s_cbranch_scc1 L_w5
    s_cmp_eq_u32 s52, 6
    s_cbranch_scc1 L_w6
    v_lshrrev_b32 v6, 4, v0
    v_and_b32 v7, 7, v0
    v_xor_b32 v7, v7, v6
    v_lshlrev_b32 v7, 4, v7
    v_lshrrev_b32 v8, 3, v0
    v_lshl_add_u32 v112, v8, 10, v7
    v_xor_b32 v113, 64, v112
    v_add_u32 v113, 7168, v113
    v_add_u32 v114, 14336, v112
    v_add_u32 v115, 14336, v113
    v_lshrrev_b32 v7, 2, v0
    v_xor_b32 v6, v6, v7
    v_and_b32 v6, 1, v6
    v_lshlrev_b32 v6, 6, v6
    v_and_b32 v7, 3, v0
    v_lshl_add_u32 v6, v7, 4, v6
    v_lshl_add_u32 v116, v8, 10, v6
    v_mul_u32_u24 v8, 3072, v8
    v_add_u32 v120, v8, v6
    v_add_u32 v117, 7168, v116
    v_add_u32 v121, 23552, v120
    v_add_u32 v118, 14336, v116
    v_add_u32 v122, 47104, v120
    v_add_u32 v119, 21504, v116
    v_add_u32 v123, 70656, v120
    s_lshl_b32 s60, s53, 16
    s_lshl_b32 s65, s54, 7
    s_barrier
    s_add_u32 s64, s3, 0
    s_and_b32 s64, s64, 7
    s_lshl_b32 s61, s64, 7
    s_add_u32 s61, s61, s60
    s_lshl_b32 s62, s64, 16
    s_add_u32 s62, s62, s65
    s_mul_i32 s63, s64, 196608
    s_add_u32 s63, s63, s65
    s_mov_b32 m0, 20480
    s_add_u32 s64, s63, 98304
    buffer_load_dwordx4 v120, s[12:15], s64 offen offset:0 lds
    buffer_load_dwordx4 v121, s[12:15], s64 offen offset:1024 lds
    buffer_load_dwordx4 v122, s[12:15], s64 offen offset:2048 lds
    buffer_load_dwordx4 v123, s[12:15], s64 offen offset:3072 lds
    s_mov_b32 m0, 24576
    s_add_u32 s64, s63, 1024
    buffer_load_dwordx4 v120, s[12:15], s64 offen offset:0 lds
    buffer_load_dwordx4 v121, s[12:15], s64 offen offset:1024 lds
    buffer_load_dwordx4 v122, s[12:15], s64 offen offset:2048 lds
    buffer_load_dwordx4 v123, s[12:15], s64 offen offset:3072 lds
    s_mov_b32 m0, 28672
    s_add_u32 s64, s63, 99328
    buffer_load_dwordx4 v120, s[12:15], s64 offen offset:0 lds
    buffer_load_dwordx4 v121, s[12:15], s64 offen offset:1024 lds
    buffer_load_dwordx4 v122, s[12:15], s64 offen offset:2048 lds
    buffer_load_dwordx4 v123, s[12:15], s64 offen offset:3072 lds
    s_mov_b32 m0, 32768
    s_add_u32 s64, s63, 2048
    buffer_load_dwordx4 v120, s[12:15], s64 offen offset:0 lds
    buffer_load_dwordx4 v121, s[12:15], s64 offen offset:1024 lds
    buffer_load_dwordx4 v122, s[12:15], s64 offen offset:2048 lds
    buffer_load_dwordx4 v123, s[12:15], s64 offen offset:3072 lds
    s_mov_b32 m0, 36864
    s_add_u32 s64, s63, 100352
    buffer_load_dwordx4 v120, s[12:15], s64 offen offset:0 lds
    buffer_load_dwordx4 v121, s[12:15], s64 offen offset:1024 lds
    buffer_load_dwordx4 v122, s[12:15], s64 offen offset:2048 lds
    buffer_load_dwordx4 v123, s[12:15], s64 offen offset:3072 lds
    s_add_u32 s64, s3, 1
    s_and_b32 s64, s64, 7
    s_lshl_b32 s61, s64, 7
    s_add_u32 s61, s61, s60
    s_lshl_b32 s62, s64, 16
    s_add_u32 s62, s62, s65
    s_mul_i32 s63, s64, 196608
    s_add_u32 s63, s63, s65
    s_mov_b32 m0, 61440
    s_add_u32 s64, s63, 98304
    buffer_load_dwordx4 v120, s[12:15], s64 offen offset:0 lds
    buffer_load_dwordx4 v121, s[12:15], s64 offen offset:1024 lds
    buffer_load_dwordx4 v122, s[12:15], s64 offen offset:2048 lds
    buffer_load_dwordx4 v123, s[12:15], s64 offen offset:3072 lds
    s_mov_b32 m0, 65536
    s_add_u32 s64, s63, 1024
    buffer_load_dwordx4 v120, s[12:15], s64 offen offset:0 lds
    buffer_load_dwordx4 v121, s[12:15], s64 offen offset:1024 lds
    buffer_load_dwordx4 v122, s[12:15], s64 offen offset:2048 lds
    buffer_load_dwordx4 v123, s[12:15], s64 offen offset:3072 lds
    s_mov_b32 m0, 69632
    s_add_u32 s64, s63, 99328
    buffer_load_dwordx4 v120, s[12:15], s64 offen offset:0 lds
    buffer_load_dwordx4 v121, s[12:15], s64 offen offset:1024 lds
    buffer_load_dwordx4 v122, s[12:15], s64 offen offset:2048 lds
    buffer_load_dwordx4 v123, s[12:15], s64 offen offset:3072 lds
    s_mov_b32 m0, 73728
    s_add_u32 s64, s63, 2048
    buffer_load_dwordx4 v120, s[12:15], s64 offen offset:0 lds
    buffer_load_dwordx4 v121, s[12:15], s64 offen offset:1024 lds
    buffer_load_dwordx4 v122, s[12:15], s64 offen offset:2048 lds
    buffer_load_dwordx4 v123, s[12:15], s64 offen offset:3072 lds
    s_mov_b32 m0, 77824
    s_add_u32 s64, s63, 100352
    buffer_load_dwordx4 v120, s[12:15], s64 offen offset:0 lds
    buffer_load_dwordx4 v121, s[12:15], s64 offen offset:1024 lds
    buffer_load_dwordx4 v122, s[12:15], s64 offen offset:2048 lds
    buffer_load_dwordx4 v123, s[12:15], s64 offen offset:3072 lds
    s_waitcnt vmcnt(20)
    s_barrier
    s_add_u32 s64, s3, 2
    s_and_b32 s64, s64, 7
    s_lshl_b32 s61, s64, 7
    s_add_u32 s61, s61, s60
    s_lshl_b32 s62, s64, 16
    s_add_u32 s62, s62, s65
    s_mul_i32 s63, s64, 196608
    s_add_u32 s63, s63, s65
    s_mov_b32 m0, 102400
    s_add_u32 s64, s63, 98304
    buffer_load_dwordx4 v120, s[12:15], s64 offen offset:0 lds
    buffer_load_dwordx4 v121, s[12:15], s64 offen offset:1024 lds
    buffer_load_dwordx4 v122, s[12:15], s64 offen offset:2048 lds
    buffer_load_dwordx4 v123, s[12:15], s64 offen offset:3072 lds
    s_mov_b32 m0, 106496
    s_add_u32 s64, s63, 1024
    buffer_load_dwordx4 v120, s[12:15], s64 offen offset:0 lds
    buffer_load_dwordx4 v121, s[12:15], s64 offen offset:1024 lds
    buffer_load_dwordx4 v122, s[12:15], s64 offen offset:2048 lds
    buffer_load_dwordx4 v123, s[12:15], s64 offen offset:3072 lds
    s_mov_b32 m0, 110592
    s_add_u32 s64, s63, 99328
    buffer_load_dwordx4 v120, s[12:15], s64 offen offset:0 lds
    buffer_load_dwordx4 v121, s[12:15], s64 offen offset:1024 lds
    buffer_load_dwordx4 v122, s[12:15], s64 offen offset:2048 lds
    buffer_load_dwordx4 v123, s[12:15], s64 offen offset:3072 lds
    s_mov_b32 m0, 114688
    s_add_u32 s64, s63, 2048
    buffer_load_dwordx4 v120, s[12:15], s64 offen offset:0 lds
    buffer_load_dwordx4 v121, s[12:15], s64 offen offset:1024 lds
    buffer_load_dwordx4 v122, s[12:15], s64 offen offset:2048 lds
    buffer_load_dwordx4 v123, s[12:15], s64 offen offset:3072 lds
    s_mov_b32 m0, 118784
    s_add_u32 s64, s63, 100352
    buffer_load_dwordx4 v120, s[12:15], s64 offen offset:0 lds
    buffer_load_dwordx4 v121, s[12:15], s64 offen offset:1024 lds
    buffer_load_dwordx4 v122, s[12:15], s64 offen offset:2048 lds
    buffer_load_dwordx4 v123, s[12:15], s64 offen offset:3072 lds
    s_add_u32 s64, s3, 3
    s_and_b32 s64, s64, 7
    s_lshl_b32 s61, s64, 7
    s_add_u32 s61, s61, s60
    s_lshl_b32 s62, s64, 16
    s_add_u32 s62, s62, s65
    s_mul_i32 s63, s64, 196608
    s_add_u32 s63, s63, s65
    s_mov_b32 m0, 143360
    s_add_u32 s64, s63, 98304
    buffer_load_dwordx4 v120, s[12:15], s64 offen offset:0 lds
    buffer_load_dwordx4 v121, s[12:15], s64 offen offset:1024 lds
    buffer_load_dwordx4 v122, s[12:15], s64 offen offset:2048 lds
    buffer_load_dwordx4 v123, s[12:15], s64 offen offset:3072 lds
    s_mov_b32 m0, 147456
    s_add_u32 s64, s63, 1024
    buffer_load_dwordx4 v120, s[12:15], s64 offen offset:0 lds
    buffer_load_dwordx4 v121, s[12:15], s64 offen offset:1024 lds
    buffer_load_dwordx4 v122, s[12:15], s64 offen offset:2048 lds
    buffer_load_dwordx4 v123, s[12:15], s64 offen offset:3072 lds
    s_waitcnt vmcnt(28)
    s_barrier
    s_mov_b32 m0, 151552
    s_add_u32 s64, s63, 99328
    buffer_load_dwordx4 v120, s[12:15], s64 offen offset:0 lds
    buffer_load_dwordx4 v121, s[12:15], s64 offen offset:1024 lds
    buffer_load_dwordx4 v122, s[12:15], s64 offen offset:2048 lds
    buffer_load_dwordx4 v123, s[12:15], s64 offen offset:3072 lds
    s_mov_b32 m0, 155648
    s_add_u32 s64, s63, 2048
    buffer_load_dwordx4 v120, s[12:15], s64 offen offset:0 lds
    buffer_load_dwordx4 v121, s[12:15], s64 offen offset:1024 lds
    buffer_load_dwordx4 v122, s[12:15], s64 offen offset:2048 lds
    buffer_load_dwordx4 v123, s[12:15], s64 offen offset:3072 lds
    s_mov_b32 m0, 159744
    s_add_u32 s64, s63, 100352
    buffer_load_dwordx4 v120, s[12:15], s64 offen offset:0 lds
    buffer_load_dwordx4 v121, s[12:15], s64 offen offset:1024 lds
    buffer_load_dwordx4 v122, s[12:15], s64 offen offset:2048 lds
    buffer_load_dwordx4 v123, s[12:15], s64 offen offset:3072 lds
    s_add_u32 s64, s3, 4
    s_and_b32 s64, s64, 7
    s_lshl_b32 s61, s64, 7
    s_add_u32 s61, s61, s60
    s_lshl_b32 s62, s64, 16
    s_add_u32 s62, s62, s65
    s_mul_i32 s63, s64, 196608
    s_add_u32 s63, s63, s65
    s_mov_b32 m0, 20480
    s_add_u32 s64, s63, 98304
    buffer_load_dwordx4 v120, s[12:15], s64 offen offset:0 lds
    buffer_load_dwordx4 v121, s[12:15], s64 offen offset:1024 lds
    buffer_load_dwordx4 v122, s[12:15], s64 offen offset:2048 lds
    buffer_load_dwordx4 v123, s[12:15], s64 offen offset:3072 lds
    s_mov_b32 m0, 24576
    s_add_u32 s64, s63, 1024
    buffer_load_dwordx4 v120, s[12:15], s64 offen offset:0 lds
    buffer_load_dwordx4 v121, s[12:15], s64 offen offset:1024 lds
    buffer_load_dwordx4 v122, s[12:15], s64 offen offset:2048 lds
    buffer_load_dwordx4 v123, s[12:15], s64 offen offset:3072 lds
    s_waitcnt vmcnt(28)
    s_barrier
    s_mov_b32 m0, 28672
    s_add_u32 s64, s63, 99328
    buffer_load_dwordx4 v120, s[12:15], s64 offen offset:0 lds
    buffer_load_dwordx4 v121, s[12:15], s64 offen offset:1024 lds
    buffer_load_dwordx4 v122, s[12:15], s64 offen offset:2048 lds
    buffer_load_dwordx4 v123, s[12:15], s64 offen offset:3072 lds
    s_mov_b32 m0, 32768
    s_add_u32 s64, s63, 2048
    buffer_load_dwordx4 v120, s[12:15], s64 offen offset:0 lds
    buffer_load_dwordx4 v121, s[12:15], s64 offen offset:1024 lds
    buffer_load_dwordx4 v122, s[12:15], s64 offen offset:2048 lds
    buffer_load_dwordx4 v123, s[12:15], s64 offen offset:3072 lds
    s_mov_b32 m0, 36864
    s_add_u32 s64, s63, 100352
    buffer_load_dwordx4 v120, s[12:15], s64 offen offset:0 lds
    buffer_load_dwordx4 v121, s[12:15], s64 offen offset:1024 lds
    buffer_load_dwordx4 v122, s[12:15], s64 offen offset:2048 lds
    buffer_load_dwordx4 v123, s[12:15], s64 offen offset:3072 lds
    s_add_u32 s64, s3, 5
    s_and_b32 s64, s64, 7
    s_lshl_b32 s61, s64, 7
    s_add_u32 s61, s61, s60
    s_lshl_b32 s62, s64, 16
    s_add_u32 s62, s62, s65
    s_mul_i32 s63, s64, 196608
    s_add_u32 s63, s63, s65
    s_mov_b32 m0, 61440
    s_add_u32 s64, s63, 98304
    buffer_load_dwordx4 v120, s[12:15], s64 offen offset:0 lds
    buffer_load_dwordx4 v121, s[12:15], s64 offen offset:1024 lds
    buffer_load_dwordx4 v122, s[12:15], s64 offen offset:2048 lds
    buffer_load_dwordx4 v123, s[12:15], s64 offen offset:3072 lds
    s_mov_b32 m0, 65536
    s_add_u32 s64, s63, 1024
    buffer_load_dwordx4 v120, s[12:15], s64 offen offset:0 lds
    buffer_load_dwordx4 v121, s[12:15], s64 offen offset:1024 lds
    buffer_load_dwordx4 v122, s[12:15], s64 offen offset:2048 lds
    buffer_load_dwordx4 v123, s[12:15], s64 offen offset:3072 lds
    s_waitcnt vmcnt(28)
    s_barrier
    s_mov_b32 m0, 69632
    s_add_u32 s64, s63, 99328
    buffer_load_dwordx4 v120, s[12:15], s64 offen offset:0 lds
    buffer_load_dwordx4 v121, s[12:15], s64 offen offset:1024 lds
    buffer_load_dwordx4 v122, s[12:15], s64 offen offset:2048 lds
    buffer_load_dwordx4 v123, s[12:15], s64 offen offset:3072 lds
    s_mov_b32 m0, 73728
    s_add_u32 s64, s63, 2048
    buffer_load_dwordx4 v120, s[12:15], s64 offen offset:0 lds
    buffer_load_dwordx4 v121, s[12:15], s64 offen offset:1024 lds
    buffer_load_dwordx4 v122, s[12:15], s64 offen offset:2048 lds
    buffer_load_dwordx4 v123, s[12:15], s64 offen offset:3072 lds
    s_mov_b32 m0, 77824
    s_add_u32 s64, s63, 100352
    buffer_load_dwordx4 v120, s[12:15], s64 offen offset:0 lds
    buffer_load_dwordx4 v121, s[12:15], s64 offen offset:1024 lds
    buffer_load_dwordx4 v122, s[12:15], s64 offen offset:2048 lds
    buffer_load_dwordx4 v123, s[12:15], s64 offen offset:3072 lds
    s_add_u32 s64, s3, 6
    s_and_b32 s64, s64, 7
    s_lshl_b32 s61, s64, 7
    s_add_u32 s61, s61, s60
    s_lshl_b32 s62, s64, 16
    s_add_u32 s62, s62, s65
    s_mul_i32 s63, s64, 196608
    s_add_u32 s63, s63, s65
    s_mov_b32 m0, 102400
    s_add_u32 s64, s63, 98304
    buffer_load_dwordx4 v120, s[12:15], s64 offen offset:0 lds
    buffer_load_dwordx4 v121, s[12:15], s64 offen offset:1024 lds
    buffer_load_dwordx4 v122, s[12:15], s64 offen offset:2048 lds
    buffer_load_dwordx4 v123, s[12:15], s64 offen offset:3072 lds
    s_mov_b32 m0, 106496
    s_add_u32 s64, s63, 1024
    buffer_load_dwordx4 v120, s[12:15], s64 offen offset:0 lds
    buffer_load_dwordx4 v121, s[12:15], s64 offen offset:1024 lds
    buffer_load_dwordx4 v122, s[12:15], s64 offen offset:2048 lds
    buffer_load_dwordx4 v123, s[12:15], s64 offen offset:3072 lds
    s_waitcnt vmcnt(28)
    s_barrier
    s_mov_b32 m0, 110592
    s_add_u32 s64, s63, 99328
    buffer_load_dwordx4 v120, s[12:15], s64 offen offset:0 lds
    buffer_load_dwordx4 v121, s[12:15], s64 offen offset:1024 lds
    buffer_load_dwordx4 v122, s[12:15], s64 offen offset:2048 lds
    buffer_load_dwordx4 v123, s[12:15], s64 offen offset:3072 lds
    s_mov_b32 m0, 114688
    s_add_u32 s64, s63, 2048
    buffer_load_dwordx4 v120, s[12:15], s64 offen offset:0 lds
    buffer_load_dwordx4 v121, s[12:15], s64 offen offset:1024 lds
    buffer_load_dwordx4 v122, s[12:15], s64 offen offset:2048 lds
    buffer_load_dwordx4 v123, s[12:15], s64 offen offset:3072 lds
    s_mov_b32 m0, 118784
    s_add_u32 s64, s63, 100352
    buffer_load_dwordx4 v120, s[12:15], s64 offen offset:0 lds
    buffer_load_dwordx4 v121, s[12:15], s64 offen offset:1024 lds
    buffer_load_dwordx4 v122, s[12:15], s64 offen offset:2048 lds
    buffer_load_dwordx4 v123, s[12:15], s64 offen offset:3072 lds
    s_add_u32 s64, s3, 7
    s_and_b32 s64, s64, 7
    s_lshl_b32 s61, s64, 7
    s_add_u32 s61, s61, s60
    s_lshl_b32 s62, s64, 16
    s_add_u32 s62, s62, s65
    s_mul_i32 s63, s64, 196608
    s_add_u32 s63, s63, s65
    s_mov_b32 m0, 143360
    s_add_u32 s64, s63, 98304
    buffer_load_dwordx4 v120, s[12:15], s64 offen offset:0 lds
    buffer_load_dwordx4 v121, s[12:15], s64 offen offset:1024 lds
    buffer_load_dwordx4 v122, s[12:15], s64 offen offset:2048 lds
    buffer_load_dwordx4 v123, s[12:15], s64 offen offset:3072 lds
    s_mov_b32 m0, 147456
    s_add_u32 s64, s63, 1024
    buffer_load_dwordx4 v120, s[12:15], s64 offen offset:0 lds
    buffer_load_dwordx4 v121, s[12:15], s64 offen offset:1024 lds
    buffer_load_dwordx4 v122, s[12:15], s64 offen offset:2048 lds
    buffer_load_dwordx4 v123, s[12:15], s64 offen offset:3072 lds
    s_waitcnt vmcnt(28)
    s_barrier
    s_mov_b32 m0, 151552
    s_add_u32 s64, s63, 99328
    buffer_load_dwordx4 v120, s[12:15], s64 offen offset:0 lds
    buffer_load_dwordx4 v121, s[12:15], s64 offen offset:1024 lds
    buffer_load_dwordx4 v122, s[12:15], s64 offen offset:2048 lds
    buffer_load_dwordx4 v123, s[12:15], s64 offen offset:3072 lds
    s_mov_b32 m0, 155648
    s_add_u32 s64, s63, 2048
    buffer_load_dwordx4 v120, s[12:15], s64 offen offset:0 lds
    buffer_load_dwordx4 v121, s[12:15], s64 offen offset:1024 lds
    buffer_load_dwordx4 v122, s[12:15], s64 offen offset:2048 lds
    buffer_load_dwordx4 v123, s[12:15], s64 offen offset:3072 lds
    s_mov_b32 m0, 159744
    s_add_u32 s64, s63, 100352
    buffer_load_dwordx4 v120, s[12:15], s64 offen offset:0 lds
    buffer_load_dwordx4 v121, s[12:15], s64 offen offset:1024 lds
    buffer_load_dwordx4 v122, s[12:15], s64 offen offset:2048 lds
    buffer_load_dwordx4 v123, s[12:15], s64 offen offset:3072 lds
    s_waitcnt vmcnt(20)
    s_barrier
    s_call_b64 s[44:45], L_setup1
    s_waitcnt vmcnt(0)
    s_barrier
    s_call_b64 s[44:45], L_setup2
    s_branch L_kvb
L_w4:
    s_lshr_b32 s64, s54, 1
    s_lshl_b32 s60, s53, 2
    s_add_u32 s60, s60, s64
    s_lshl_b32 s60, s60, 14
    s_mov_b32 m0, 131072
    v_xor_b32 v120, 0, v1
    buffer_load_dwordx4 v120, s[8:11], s60 offen offset:0 lds
    v_xor_b32 v121, 16, v1
    buffer_load_dwordx4 v121, s[8:11], s60 offen offset:1024 lds
    v_xor_b32 v122, 32, v1
    buffer_load_dwordx4 v122, s[8:11], s60 offen offset:2048 lds
    v_xor_b32 v123, 48, v1
    buffer_load_dwordx4 v123, s[8:11], s60 offen offset:3072 lds
    s_mov_b32 m0, 135168
    s_add_u32 s60, s60, 4096
    v_xor_b32 v120, 64, v1
    buffer_load_dwordx4 v120, s[8:11], s60 offen offset:0 lds
    v_xor_b32 v121, 80, v1
    buffer_load_dwordx4 v121, s[8:11], s60 offen offset:1024 lds
    v_xor_b32 v122, 96, v1
    buffer_load_dwordx4 v122, s[8:11], s60 offen offset:2048 lds
    v_xor_b32 v123, 112, v1
    buffer_load_dwordx4 v123, s[8:11], s60 offen offset:3072 lds
    s_mov_b32 m0, 139264
    s_add_u32 s60, s60, 4096
    v_xor_b32 v120, 128, v1
    buffer_load_dwordx4 v120, s[8:11], s60 offen offset:0 lds
    v_xor_b32 v121, 144, v1
    buffer_load_dwordx4 v121, s[8:11], s60 offen offset:1024 lds
    v_xor_b32 v122, 160, v1
    buffer_load_dwordx4 v122, s[8:11], s60 offen offset:2048 lds
    v_xor_b32 v123, 176, v1
    buffer_load_dwordx4 v123, s[8:11], s60 offen offset:3072 lds
    s_mov_b32 m0, 143360
    s_add_u32 s60, s60, 4096
    v_xor_b32 v120, 192, v1
    buffer_load_dwordx4 v120, s[8:11], s60 offen offset:0 lds
    v_xor_b32 v121, 208, v1
    buffer_load_dwordx4 v121, s[8:11], s60 offen offset:1024 lds
    v_xor_b32 v122, 224, v1
    buffer_load_dwordx4 v122, s[8:11], s60 offen offset:2048 lds
    v_xor_b32 v123, 240, v1
    buffer_load_dwordx4 v123, s[8:11], s60 offen offset:3072 lds
    s_bitcmp1_b32 s54, 0
    s_cselect_b32 s20, s40, s38
    s_cselect_b32 s21, s41, s39
    s_mov_b32 s22, 16384
    s_mov_b32 s23, 0x00020000
    s_mov_b32 s60, 0
    s_mov_b32 m0, 147456
    s_nop 0
    buffer_load_dwordx4 v1, s[20:23], s60 offen offset:0 lds
    buffer_load_dwordx4 v1, s[20:23], s60 offen offset:1024 lds
    buffer_load_dwordx4 v1, s[20:23], s60 offen offset:2048 lds
    buffer_load_dwordx4 v1, s[20:23], s60 offen offset:3072 lds
    s_mov_b32 m0, 151552
    s_add_u32 s60, s60, 4096
    buffer_load_dwordx4 v1, s[20:23], s60 offen offset:0 lds
    buffer_load_dwordx4 v1, s[20:23], s60 offen offset:1024 lds
    buffer_load_dwordx4 v1, s[20:23], s60 offen offset:2048 lds
    buffer_load_dwordx4 v1, s[20:23], s60 offen offset:3072 lds
    s_mov_b32 m0, 155648
    s_add_u32 s60, s60, 4096
    buffer_load_dwordx4 v1, s[20:23], s60 offen offset:0 lds
    buffer_load_dwordx4 v1, s[20:23], s60 offen offset:1024 lds
    buffer_load_dwordx4 v1, s[20:23], s60 offen offset:2048 lds
    buffer_load_dwordx4 v1, s[20:23], s60 offen offset:3072 lds
    s_mov_b32 m0, 159744
    s_add_u32 s60, s60, 4096
    buffer_load_dwordx4 v1, s[20:23], s60 offen offset:0 lds
    buffer_load_dwordx4 v1, s[20:23], s60 offen offset:1024 lds
    buffer_load_dwordx4 v1, s[20:23], s60 offen offset:2048 lds
    buffer_load_dwordx4 v1, s[20:23], s60 offen offset:3072 lds
    s_barrier
    s_mov_b32 s24, s44
    s_mov_b32 s25, s45
    s_mov_b32 s26, 1024
    s_mov_b32 s27, 0x00020000
    s_bitcmp1_b32 s54, 0
    s_cbranch_scc1 L_w4ng
    v_lshrrev_b32 v6, 4, v0
    v_lshlrev_b32 v6, 4, v6
    s_mov_b32 s70, 0x00010001
    s_mov_b32 s71, 0x00010001
    s_mov_b64 exec, s[70:71]
    buffer_load_dwordx4 v[128:131], v6, s[24:27], 0 offen offset:0
    buffer_load_dwordx4 v[132:135], v6, s[24:27], 0 offen offset:64
    buffer_load_dwordx4 v[136:139], v6, s[24:27], 0 offen offset:128
    buffer_load_dwordx4 v[140:143], v6, s[24:27], 0 offen offset:192
    buffer_load_dwordx4 v[144:147], v6, s[24:27], 0 offen offset:256
    buffer_load_dwordx4 v[148:151], v6, s[24:27], 0 offen offset:320
    buffer_load_dwordx4 v[152:155], v6, s[24:27], 0 offen offset:384
    buffer_load_dwordx4 v[156:159], v6, s[24:27], 0 offen offset:448
    buffer_load_dwordx4 v[160:163], v6, s[24:27], 0 offen offset:512
    buffer_load_dwordx4 v[164:167], v6, s[24:27], 0 offen offset:576
    buffer_load_dwordx4 v[168:171], v6, s[24:27], 0 offen offset:640
    buffer_load_dwordx4 v[172:175], v6, s[24:27], 0 offen offset:704
    buffer_load_dwordx4 v[176:179], v6, s[24:27], 0 offen offset:768
    buffer_load_dwordx4 v[180:183], v6, s[24:27], 0 offen offset:832
    buffer_load_dwordx4 v[184:187], v6, s[24:27], 0 offen offset:896
    buffer_load_dwordx4 v[188:191], v6, s[24:27], 0 offen offset:960
    s_mov_b64 exec, -1
L_w4ng:
    s_mov_b32 s28, s50
    s_mov_b32 s29, s51
    s_mov_b32 s30, 16777216
    s_mov_b32 s31, 0x00020000
    v_and_b32 v6, 15, v0
    v_lshrrev_b32 v7, 4, v0
    v_xor_b32 v7, v7, v6
    v_lshlrev_b32 v7, 4, v7
    v_lshl_add_u32 v112, v6, 10, v7
    v_add_u32 v112, 131072, v112
    v_xor_b32 v113, 64, v112
    v_xor_b32 v114, 128, v112
    v_xor_b32 v115, 192, v112
    v_bfe_u32 v6, v0, 2, 2
    v_lshrrev_b32 v7, 4, v0
    v_lshl_add_u32 v6, v7, 3, v6
    v_and_b32 v7, 3, v0
    v_lshlrev_b32 v7, 3, v7
    v_lshl_add_u32 v116, v6, 5, v7
    v_add_u32 v116, 147456, v116
    v_and_b32 v6, 15, v0
    s_and_b32 s61, s64, 1
    s_lshl_b32 s62, s61, 4
    v_add_u32 v9, s62, v6
    v_and_b32 v117, 0x13, v9
    v_and_b32 v7, 4, v9
    v_lshl_or_b32 v117, v7, 1, v117
    v_and_b32 v7, 8, v9
    v_lshrrev_b32 v7, 1, v7
    v_or_b32 v117, v117, v7
    v_bfe_u32 v7, v0, 4, 1
    v_lshl_add_u32 v117, v7, 5, v117
    v_lshl_add_u32 v118, v7, 4, v6
    s_lshl_b32 s62, s61, 9
    s_add_u32 s62, s62, 1024
    v_lshlrev_b32 v118, 4, v118
    v_add_u32 v118, s62, v118
    v_lshlrev_b32 v117, 4, v117
    s_bitcmp1_b32 s54, 0
    s_cselect_b64 vcc, -1, 0
    v_lshrrev_b32 v7, 5, v0
    v_cndmask_b32 v117, v117, v118, vcc
    v_lshl_add_u32 v117, v7, 3, v117
    s_lshl_b32 s60, s53, 1
    s_lshr_b32 s61, s64, 1
    s_add_u32 s60, s60, s61
    s_lshl_b32 s60, s60, 11
    s_add_u32 s60, s60, 8388608
    s_lshr_b32 s61, s2, 2
    s_lshl_b32 s61, s61, 6
    s_and_b32 s62, s2, 3
    s_lshl_b32 s62, s62, 2
    s_add_u32 s61, s61, s62
    s_add_u32 s61, s61, 13635584
    s_waitcnt vmcnt(0) lgkmcnt(0)
    s_add_u32 s55, s55, 1
    s_bitcmp1_b32 s54, 0
    s_cbranch_scc1 L_w4v
    ds_read_b128 v[16:19], v112 offset:0
    ds_read_b64_tr_b16 v[20:21], v116 offset:0
    ds_read_b64_tr_b16 v[22:23], v116 offset:128
    ds_read_b128 v[24:27], v113 offset:0
    ds_read_b64_tr_b16 v[28:29], v116 offset:1024
    ds_read_b64_tr_b16 v[30:31], v116 offset:1152
    ds_read_b128 v[32:35], v114 offset:0
    ds_read_b64_tr_b16 v[36:37], v116 offset:2048
    ds_read_b64_tr_b16 v[38:39], v116 offset:2176
    ds_read_b128 v[40:43], v115 offset:0
    ds_read_b64_tr_b16 v[44:45], v116 offset:3072
    ds_read_b64_tr_b16 v[46:47], v116 offset:3200
    s_waitcnt lgkmcnt(0)
    ds_read_b128 v[48:51], v112 offset:256
    ds_read_b64_tr_b16 v[52:53], v116 offset:4096
    ds_read_b64_tr_b16 v[54:55], v116 offset:4224
    ds_read_b128 v[56:59], v113 offset:256
    ds_read_b64_tr_b16 v[60:61], v116 offset:5120
    ds_read_b64_tr_b16 v[62:63], v116 offset:5248
    ds_read_b128 v[64:67], v114 offset:256
    ds_read_b64_tr_b16 v[68:69], v116 offset:6144
    ds_read_b64_tr_b16 v[70:71], v116 offset:6272
    ds_read_b128 v[72:75], v115 offset:256
    ds_read_b64_tr_b16 v[76:77], v116 offset:7168
    ds_read_b64_tr_b16 v[78:79], v116 offset:7296
    v_mfma_f32_16x16x32_bf16 v[12:15], v[20:23], v[16:19], 0
    v_mfma_f32_16x16x32_bf16 v[120:123], v[128:131], v[16:19], 0
    v_mfma_f32_16x16x32_bf16 v[12:15], v[28:31], v[24:27], v[12:15]
    v_mfma_f32_16x16x32_bf16 v[120:123], v[132:135], v[24:27], v[120:123]
    v_mfma_f32_16x16x32_bf16 v[12:15], v[36:39], v[32:35], v[12:15]
    v_mfma_f32_16x16x32_bf16 v[120:123], v[136:139], v[32:35], v[120:123]
    v_mfma_f32_16x16x32_bf16 v[12:15], v[44:47], v[40:43], v[12:15]
    v_mfma_f32_16x16x32_bf16 v[120:123], v[140:143], v[40:43], v[120:123]
    s_waitcnt lgkmcnt(0)
    ds_read_b128 v[16:19], v112 offset:512
    ds_read_b64_tr_b16 v[20:21], v116 offset:8192
    ds_read_b64_tr_b16 v[22:23], v116 offset:8320
    ds_read_b128 v[24:27], v113 offset:512
    ds_read_b64_tr_b16 v[28:29], v116 offset:9216
    ds_read_b64_tr_b16 v[30:31], v116 offset:9344
    ds_read_b128 v[32:35], v114 offset:512
    ds_read_b64_tr_b16 v[36:37], v116 offset:10240
    ds_read_b64_tr_b16 v[38:39], v116 offset:10368
    ds_read_b128 v[40:43], v115 offset:512
    ds_read_b64_tr_b16 v[44:45], v116 offset:11264
    ds_read_b64_tr_b16 v[46:47], v116 offset:11392
    v_mfma_f32_16x16x32_bf16 v[12:15], v[52:55], v[48:51], v[12:15]
    v_mfma_f32_16x16x32_bf16 v[120:123], v[144:147], v[48:51], v[120:123]
    v_mfma_f32_16x16x32_bf16 v[12:15], v[60:63], v[56:59], v[12:15]
    v_mfma_f32_16x16x32_bf16 v[120:123], v[148:151], v[56:59], v[120:123]
    v_mfma_f32_16x16x32_bf16 v[12:15], v[68:71], v[64:67], v[12:15]
    v_mfma_f32_16x16x32_bf16 v[120:123], v[152:155], v[64:67], v[120:123]
    v_mfma_f32_16x16x32_bf16 v[12:15], v[76:79], v[72:75], v[12:15]
    v_mfma_f32_16x16x32_bf16 v[120:123], v[156:159], v[72:75], v[120:123]
    s_waitcnt lgkmcnt(0)
    ds_read_b128 v[48:51], v112 offset:768
    ds_read_b64_tr_b16 v[52:53], v116 offset:12288
    ds_read_b64_tr_b16 v[54:55], v116 offset:12416
    ds_read_b128 v[56:59], v113 offset:768
    ds_read_b64_tr_b16 v[60:61], v116 offset:13312
    ds_read_b64_tr_b16 v[62:63], v116 offset:13440
    ds_read_b128 v[64:67], v114 offset:768
    ds_read_b64_tr_b16 v[68:69], v116 offset:14336
    ds_read_b64_tr_b16 v[70:71], v116 offset:14464
    ds_read_b128 v[72:75], v115 offset:768
    ds_read_b64_tr_b16 v[76:77], v116 offset:15360
    ds_read_b64_tr_b16 v[78:79], v116 offset:15488
    v_mfma_f32_16x16x32_bf16 v[12:15], v[20:23], v[16:19], v[12:15]
    v_mfma_f32_16x16x32_bf16 v[120:123], v[160:163], v[16:19], v[120:123]
    v_mfma_f32_16x16x32_bf16 v[12:15], v[28:31], v[24:27], v[12:15]
    v_mfma_f32_16x16x32_bf16 v[120:123], v[164:167], v[24:27], v[120:123]
    v_mfma_f32_16x16x32_bf16 v[12:15], v[36:39], v[32:35], v[12:15]
    v_mfma_f32_16x16x32_bf16 v[120:123], v[168:171], v[32:35], v[120:123]
    v_mfma_f32_16x16x32_bf16 v[12:15], v[44:47], v[40:43], v[12:15]
    v_mfma_f32_16x16x32_bf16 v[120:123], v[172:175], v[40:43], v[120:123]
    s_waitcnt lgkmcnt(0)
    v_mfma_f32_16x16x32_bf16 v[12:15], v[52:55], v[48:51], v[12:15]
    v_mfma_f32_16x16x32_bf16 v[120:123], v[176:179], v[48:51], v[120:123]
    v_mfma_f32_16x16x32_bf16 v[12:15], v[60:63], v[56:59], v[12:15]
    v_mfma_f32_16x16x32_bf16 v[120:123], v[180:183], v[56:59], v[120:123]
    v_mfma_f32_16x16x32_bf16 v[12:15], v[68:71], v[64:67], v[12:15]
    v_mfma_f32_16x16x32_bf16 v[120:123], v[184:187], v[64:67], v[120:123]
    v_mfma_f32_16x16x32_bf16 v[12:15], v[76:79], v[72:75], v[12:15]
    v_mfma_f32_16x16x32_bf16 v[120:123], v[188:191], v[72:75], v[120:123]
    s_nop 7
    v_cvt_pk_bf16_f32 v12, v12, v13
    v_cvt_pk_bf16_f32 v13, v14, v15
    buffer_store_dwordx2 v[12:13], v117, s[28:31], s60 offen sc1
    v_mul_f32 v120, 0xbfb8aa3b, v120
    v_exp_f32 v120, v120
    s_lshl_b32 s60, s53, 2
    s_add_u32 s60, s60, s64
    v_add_f32 v120, 1.0, v120
    v_rcp_f32 v120, v120
    s_lshl_b32 s60, s60, 6
    s_add_u32 s60, s60, 8912896
    v_lshlrev_b32 v6, 2, v0
    s_mov_b64 exec, 0xffff
    buffer_store_dword v120, v6, s[28:31], s60 offen sc1
    s_mov_b64 exec, -1
    s_branch L_w4b
L_w4v:
    ds_read_b128 v[16:19], v112 offset:0
    ds_read_b64_tr_b16 v[20:21], v116 offset:0
    ds_read_b64_tr_b16 v[22:23], v116 offset:128
    ds_read_b128 v[24:27], v113 offset:0
    ds_read_b64_tr_b16 v[28:29], v116 offset:1024
    ds_read_b64_tr_b16 v[30:31], v116 offset:1152
    ds_read_b128 v[32:35], v114 offset:0
    ds_read_b64_tr_b16 v[36:37], v116 offset:2048
    ds_read_b64_tr_b16 v[38:39], v116 offset:2176
    ds_read_b128 v[40:43], v115 offset:0
    ds_read_b64_tr_b16 v[44:45], v116 offset:3072
    ds_read_b64_tr_b16 v[46:47], v116 offset:3200
    s_waitcnt lgkmcnt(0)
    ds_read_b128 v[48:51], v112 offset:256
    ds_read_b64_tr_b16 v[52:53], v116 offset:4096
    ds_read_b64_tr_b16 v[54:55], v116 offset:4224
    ds_read_b128 v[56:59], v113 offset:256
    ds_read_b64_tr_b16 v[60:61], v116 offset:5120
    ds_read_b64_tr_b16 v[62:63], v116 offset:5248
    ds_read_b128 v[64:67], v114 offset:256
    ds_read_b64_tr_b16 v[68:69], v116 offset:6144
    ds_read_b64_tr_b16 v[70:71], v116 offset:6272
    ds_read_b128 v[72:75], v115 offset:256
    ds_read_b64_tr_b16 v[76:77], v116 offset:7168
    ds_read_b64_tr_b16 v[78:79], v116 offset:7296
    v_mfma_f32_16x16x32_bf16 v[12:15], v[16:19], v[20:23], 0
    v_mfma_f32_16x16x32_bf16 v[12:15], v[24:27], v[28:31], v[12:15]
    v_mfma_f32_16x16x32_bf16 v[12:15], v[32:35], v[36:39], v[12:15]
    v_mfma_f32_16x16x32_bf16 v[12:15], v[40:43], v[44:47], v[12:15]
    s_waitcnt lgkmcnt(0)
    ds_read_b128 v[16:19], v112 offset:512
    ds_read_b64_tr_b16 v[20:21], v116 offset:8192
    ds_read_b64_tr_b16 v[22:23], v116 offset:8320
    ds_read_b128 v[24:27], v113 offset:512
    ds_read_b64_tr_b16 v[28:29], v116 offset:9216
    ds_read_b64_tr_b16 v[30:31], v116 offset:9344
    ds_read_b128 v[32:35], v114 offset:512
    ds_read_b64_tr_b16 v[36:37], v116 offset:10240
    ds_read_b64_tr_b16 v[38:39], v116 offset:10368
    ds_read_b128 v[40:43], v115 offset:512
    ds_read_b64_tr_b16 v[44:45], v116 offset:11264
    ds_read_b64_tr_b16 v[46:47], v116 offset:11392
    v_mfma_f32_16x16x32_bf16 v[12:15], v[48:51], v[52:55], v[12:15]
    v_mfma_f32_16x16x32_bf16 v[12:15], v[56:59], v[60:63], v[12:15]
    v_mfma_f32_16x16x32_bf16 v[12:15], v[64:67], v[68:71], v[12:15]
    v_mfma_f32_16x16x32_bf16 v[12:15], v[72:75], v[76:79], v[12:15]
    s_waitcnt lgkmcnt(0)
    ds_read_b128 v[48:51], v112 offset:768
    ds_read_b64_tr_b16 v[52:53], v116 offset:12288
    ds_read_b64_tr_b16 v[54:55], v116 offset:12416
    ds_read_b128 v[56:59], v113 offset:768
    ds_read_b64_tr_b16 v[60:61], v116 offset:13312
    ds_read_b64_tr_b16 v[62:63], v116 offset:13440
    ds_read_b128 v[64:67], v114 offset:768
    ds_read_b64_tr_b16 v[68:69], v116 offset:14336
    ds_read_b64_tr_b16 v[70:71], v116 offset:14464
    ds_read_b128 v[72:75], v115 offset:768
    ds_read_b64_tr_b16 v[76:77], v116 offset:15360
    ds_read_b64_tr_b16 v[78:79], v116 offset:15488
    v_mfma_f32_16x16x32_bf16 v[12:15], v[16:19], v[20:23], v[12:15]
    v_mfma_f32_16x16x32_bf16 v[12:15], v[24:27], v[28:31], v[12:15]
    v_mfma_f32_16x16x32_bf16 v[12:15], v[32:35], v[36:39], v[12:15]
    v_mfma_f32_16x16x32_bf16 v[12:15], v[40:43], v[44:47], v[12:15]
    s_waitcnt lgkmcnt(0)
    v_mfma_f32_16x16x32_bf16 v[12:15], v[48:51], v[52:55], v[12:15]
    v_mfma_f32_16x16x32_bf16 v[12:15], v[56:59], v[60:63], v[12:15]
    v_mfma_f32_16x16x32_bf16 v[12:15], v[64:67], v[68:71], v[12:15]
    v_mfma_f32_16x16x32_bf16 v[12:15], v[72:75], v[76:79], v[12:15]
    s_nop 7
    v_cvt_pk_bf16_f32 v12, v12, v13
    v_cvt_pk_bf16_f32 v13, v14, v15
    buffer_store_dwordx2 v[12:13], v117, s[28:31], s60 offen sc1
    s_branch L_w4b
L_w4b:
    s_mov_b32 s78, s61
    s_barrier
    s_waitcnt vmcnt(0)
    v_mov_b32 v6, 0
    v_mov_b32 v7, s55
    s_mov_b64 exec, 1
    buffer_store_dword v7, v6, s[28:31], s78 offen sc1
    s_mov_b64 exec, -1
    s_barrier
    s_call_b64 s[44:45], L_setup1
    s_barrier
    s_call_b64 s[44:45], L_setup2
    s_barrier
    s_barrier
    s_barrier
    s_branch L_w45
L_w5:
    s_barrier
    s_getpc_b64 s[4:5]
L_pc:
    s_sub_u32 s4, s4, L_pc-gated_mix__mha_block__grouped_kv_mqa__prompt_kernel
    s_subb_u32 s5, s5, 0
    s_lshr_b32 s60, s2, 3
    s_lshl_b32 s60, s60, 3
    v_add_u32 v6, s60, v0
    v_lshlrev_b32 v6, 7, v6
    v_min_u32 v6, L_done-gated_mix__mha_block__grouped_kv_mqa__prompt_kernel, v6
    s_mov_b64 exec, 0xff
    global_load_dword v24, v6, s[4:5]
    s_mov_b64 exec, -1
    s_waitcnt lgkmcnt(0)
    s_add_u32 s55, s55, 1
    s_call_b64 s[44:45], L_setup1
    s_call_b64 s[44:45], L_setup2
    s_barrier
    s_barrier
    s_barrier
    s_barrier
    s_barrier
    s_barrier
L_w45:
    s_mov_b32 s16, s42
    s_mov_b32 s17, s43
    s_mov_b32 s18, 524288
    s_mov_b32 s19, 0x00020000
    s_mov_b32 s12, s48
    s_mov_b32 s13, s49
    s_mov_b32 s14, 524288
    s_mov_b32 s15, 0x00020000
    s_mov_b32 s8, s46
    s_mov_b32 s9, s47
    s_mov_b32 s10, 2097152
    s_mov_b32 s11, 0x00020000
    s_add_u32 s20, s50, 8388608
    s_addc_u32 s21, s51, 0
    s_mov_b32 s22, 131072
    s_mov_b32 s23, 0x00020000
    v_lshlrev_b32 v6, 6, v0
    s_mov_b32 s60, 13635584
    buffer_load_dwordx4 v[12:15], v6, s[28:31], s60 offen sc1
    s_barrier
    s_mov_b32 s78, 300000
    s_waitcnt vmcnt(0)
    v_cmp_ne_u32 vcc, s55, v12
    v_cmp_ne_u32 s[70:71], s55, v13
    s_or_b64 vcc, vcc, s[70:71]
    v_cmp_ne_u32 s[70:71], s55, v14
    v_cmp_ne_u32 s[72:73], s55, v15
    s_or_b64 vcc, vcc, s[70:71]
    s_or_b64 vcc, vcc, s[72:73]
    s_cbranch_vccz L_f1_early
    buffer_load_dwordx4 v[12:15], v6, s[28:31], s60 offen sc1
    s_barrier
L_f1_spin:
    s_waitcnt vmcnt(0)
    v_cmp_ne_u32 vcc, s55, v12
    v_cmp_ne_u32 s[70:71], s55, v13
    s_or_b64 vcc, vcc, s[70:71]
    v_cmp_ne_u32 s[70:71], s55, v14
    v_cmp_ne_u32 s[72:73], s55, v15
    s_or_b64 vcc, vcc, s[70:71]
    s_or_b64 vcc, vcc, s[72:73]
    s_cbranch_vccz L_f1_go
    buffer_load_dwordx4 v[12:15], v6, s[28:31], s60 offen sc1
    s_sub_u32 s78, s78, 1
    s_cmp_lg_u32 s78, 0
    s_cbranch_scc1 L_f1_spin
    s_branch L_f1_go
L_f1_early:
    s_barrier
L_f1_go:
    s_and_b32 s60, s52, 1
    s_lshl_b32 s60, s60, 16
    s_mov_b32 m0, s60
    s_nop 0
    buffer_load_dwordx4 v1, s[20:23], s60 offen offset:0 sc1 lds
    buffer_load_dwordx4 v1, s[20:23], s60 offen offset:1024 sc1 lds
    buffer_load_dwordx4 v1, s[20:23], s60 offen offset:2048 sc1 lds
    buffer_load_dwordx4 v1, s[20:23], s60 offen offset:3072 sc1 lds
    s_add_u32 s60, s60, 4096
    s_mov_b32 m0, s60
    s_nop 0
    buffer_load_dwordx4 v1, s[20:23], s60 offen offset:0 sc1 lds
    buffer_load_dwordx4 v1, s[20:23], s60 offen offset:1024 sc1 lds
    buffer_load_dwordx4 v1, s[20:23], s60 offen offset:2048 sc1 lds
    buffer_load_dwordx4 v1, s[20:23], s60 offen offset:3072 sc1 lds
    s_add_u32 s60, s60, 4096
    s_mov_b32 m0, s60
    s_nop 0
    buffer_load_dwordx4 v1, s[20:23], s60 offen offset:0 sc1 lds
    buffer_load_dwordx4 v1, s[20:23], s60 offen offset:1024 sc1 lds
    buffer_load_dwordx4 v1, s[20:23], s60 offen offset:2048 sc1 lds
    buffer_load_dwordx4 v1, s[20:23], s60 offen offset:3072 sc1 lds
    s_add_u32 s60, s60, 4096
    s_mov_b32 m0, s60
    s_nop 0
    buffer_load_dwordx4 v1, s[20:23], s60 offen offset:0 sc1 lds
    buffer_load_dwordx4 v1, s[20:23], s60 offen offset:1024 sc1 lds
    buffer_load_dwordx4 v1, s[20:23], s60 offen offset:2048 sc1 lds
    buffer_load_dwordx4 v1, s[20:23], s60 offen offset:3072 sc1 lds
    s_branch L_kvb2
L_kvb:
    s_waitcnt lgkmcnt(0)
    s_add_u32 s55, s55, 1
    s_mov_b32 s16, s42
    s_mov_b32 s17, s43
    s_mov_b32 s18, 524288
    s_mov_b32 s19, 0x00020000
    s_mov_b32 s12, s48
    s_mov_b32 s13, s49
    s_mov_b32 s14, 524288
    s_mov_b32 s15, 0x00020000
    s_mov_b32 s8, s46
    s_mov_b32 s9, s47
    s_mov_b32 s10, 2097152
    s_mov_b32 s11, 0x00020000
    s_add_u32 s20, s50, 8388608
    s_addc_u32 s21, s51, 0
    s_mov_b32 s22, 131072
    s_mov_b32 s23, 0x00020000
L_kvb2:
    s_barrier
    s_waitcnt vmcnt(0)
    s_barrier
    s_branch L_p_end
L_setup1:
    s_lshl_b32 s32, s76, 16
    s_lshl_b32 s33, s76, 14
    s_add_u32 s33, s33, 131072
    s_mul_i32 s34, s77, 12288
    s_add_u32 s34, s34, s32
    s_add_u32 s34, s34, 16384
    v_and_b32 v6, 15, v0
    v_lshrrev_b32 v8, 5, v0
    v_lshl_add_u32 v6, v8, 4, v6
    v_lshlrev_b32 v196, 4, v6
    v_add_u32 v2, s32, v1
    v_add_u32 v3, s32, v196
    v_mov_b32 v4, 0xdddddddd
    v_and_b32 v6, 27, v0
    v_cmp_eq_u32 vcc, 16, v6
    v_mov_b32 v8, 0x3f803f80
    s_lshl_b32 s60, s77, 11
    s_add_u32 s60, s60, 131072
    v_cndmask_b32 v8, 0, v8, vcc
    v_add_u32 v11, s60, v1
    s_mov_b32 s59, 0
    s_mov_b32 s7, 0
    v_accvgpr_write_b32 a20, v8
    v_accvgpr_write_b32 a21, v8
    v_accvgpr_write_b32 a22, v8
    v_accvgpr_write_b32 a23, v8
    v_accvgpr_write_b32 a24, v8
    v_accvgpr_write_b32 a25, v8
    v_accvgpr_write_b32 a26, v8
    v_accvgpr_write_b32 a27, v8
    v_accvgpr_write_b32 a32, v8
    v_accvgpr_write_b32 a33, v8
    v_accvgpr_write_b32 a34, v8
    v_accvgpr_write_b32 a35, v8
    v_accvgpr_write_b32 a36, v8
    v_accvgpr_write_b32 a37, v8
    v_accvgpr_write_b32 a38, v8
    v_accvgpr_write_b32 a39, v8
    s_mul_i32 s60, s77, 2560
    s_add_u32 s60, s60, s32
    v_add_u32 v197, s60, v1
    v_lshrrev_b32 v9, 1, v1
    v_add_u32 v198, s60, v9
    s_and_b32 s60, s77, 1
    s_mul_i32 s60, s60, 5120
    s_lshr_b32 s61, s77, 1
    s_lshl_b32 s61, s61, 16
    s_add_u32 s60, s60, s61
    s_add_u32 s60, s60, 49152
    v_add_u32 v184, s60, v1
    v_add_u32 v185, s60, v9
    s_lshl_b32 s35, s53, 1
    s_lshr_b32 s60, s77, 1
    s_add_u32 s35, s35, s60
    s_lshl_b32 s35, s35, 6
    s_lshl_b32 s60, s54, 1
    s_and_b32 s61, s77, 1
    s_add_u32 s60, s60, s61
    s_lshl_b32 s60, s60, 1
    s_add_u32 s60, s60, s76
    s_add_u32 s35, s35, s60
    s_lshl_b32 s35, s35, 10
    s_add_u32 s35, s35, 9469952
    s_lshr_b32 s60, s53, 2
    s_lshl_b32 s60, s60, 2
    s_add_u32 s60, s60, s77
    s_lshl_b32 s60, s60, 1
    s_lshl_b32 s61, s54, 2
    s_and_b32 s62, s53, 3
    s_add_u32 s61, s61, s62
    s_lshl_b32 s36, s60, 6
    s_add_u32 s36, s36, s61
    s_lshl_b32 s36, s36, 10
    s_add_u32 s36, s36, 9437184
    s_lshl_b32 s39, s61, 6
    s_add_u32 s39, s39, s60
    s_lshl_b32 s39, s39, 10
    s_lshl_b32 s40, s61, 17
    s_add_u32 s40, s40, 4194304
    s_lshl_b32 s41, s77, 12
    s_add_u32 s41, s41, s32
    s_lshl_b32 s37, s54, 5
    s_add_u32 s37, s37, s53
    s_lshl_b32 s37, s37, 2
    s_add_u32 s37, s37, s52
    s_lshl_b32 s37, s37, 2
    s_add_u32 s37, s37, 13639680
    s_lshl_b32 s79, s53, 8
    s_add_u32 s79, s79, 13647872
    s_lshl_b32 s38, s54, 3
    s_add_u32 s38, s38, s52
    s_lshl_b32 s38, s38, 2
    s_add_u32 s38, s38, s79
    s_setpc_b64 s[44:45]
L_setup2:
    v_lshrrev_b32 v192, 2, v0
    v_lshrrev_b32 v193, 4, v0
    v_xor_b32 v192, v192, v193
    v_and_b32 v192, 1, v192
    v_lshlrev_b32 v192, 6, v192
    v_and_b32 v193, 3, v0
    v_lshl_add_u32 v192, v193, 4, v192
    v_lshrrev_b32 v193, 3, v0
    v_lshl_add_u32 v192, v193, 10, v192
    v_add_u32 v193, 7168, v192
    v_add_u32 v194, 14336, v192
    v_add_u32 v195, 21504, v192
    s_lshl_b32 s64, s54, 7
    s_lshl_b32 s24, s52, 15
    s_add_u32 s24, s24, s64
    s_lshl_b32 s25, s77, 12
    s_add_u32 s25, s25, s32
    s_lshl_b32 s26, s52, 16
    s_add_u32 s26, s26, s64
    s_lshl_b32 s27, s77, 13
    s_add_u32 s27, s27, s32
    s_add_u32 s27, s27, 16384
    s_and_b32 s75, s53, 7
    s_lshl_b32 s75, s75, 16
    s_add_u32 s75, s75, s64
    s_and_b32 s60, s52, 1
    s_lshr_b32 s61, s52, 1
    v_bfe_u32 v6, v0, 2, 2
    v_lshrrev_b32 v7, 5, v0
    v_lshl_add_u32 v7, v7, 2, v6
    v_bfe_u32 v8, v0, 4, 1
    v_add_u32 v8, s61, v8
    v_xor_b32 v6, v6, v8
    v_bfe_u32 v6, v6, 1, 1
    v_lshlrev_b32 v6, 6, v6
    v_lshl_add_u32 v6, v7, 7, v6
    v_and_b32 v8, 1, v8
    v_lshl_add_u32 v6, v8, 5, v6
    v_and_b32 v7, 1, v0
    v_lshl_add_u32 v6, v7, 4, v6
    v_bfe_u32 v7, v0, 1, 1
    v_lshl_add_u32 v6, v7, 3, v6
    s_lshl_b32 s62, s61, 3
    s_lshr_b32 s63, 0x60502010, s62
    s_and_b32 s63, s63, 0xff
    s_lshl_b32 s63, s63, 10
    v_add_u32 v180, s63, v6
    v_xor_b32 v181, 64, v180
    s_lshr_b32 s63, 0x40009080, s62
    s_and_b32 s63, s63, 0xff
    s_lshl_b32 s63, s63, 10
    v_add_u32 v182, s63, v6
    v_xor_b32 v183, 64, v182
    s_lshl_b32 s62, s53, 1
    s_add_u32 s62, s62, s60
    s_lshl_b32 s5, s62, 7
    s_add_u32 s5, s5, 8912896
    s_lshl_b32 s4, s62, 16
    s_lshl_b32 s63, s61, 13
    s_add_u32 s4, s4, s63
    s_add_u32 s4, s4, 9437184
    s_lshl_b32 s74, s62, 15
    s_add_u32 s74, s74, s64
    s_lshl_b32 s63, s61, 5
    s_add_u32 s74, s74, s63
    s_lshl_b32 s62, s60, 2
    s_add_u32 s63, s61, 1
    s_and_b32 s63, s63, 3
    s_add_u32 s63, s63, s62
    s_lshl_b32 s63, s63, 11
    s_add_u32 s63, s63, 131072
    v_add_u32 v186, s63, v1
    s_add_u32 s63, s61, 2
    s_and_b32 s63, s63, 3
    s_add_u32 s63, s63, s62
    s_lshl_b32 s63, s63, 11
    s_add_u32 s63, s63, 147456
    v_add_u32 v187, s63, v1
    s_add_u32 s63, s61, 3
    s_and_b32 s63, s63, 3
    s_add_u32 s63, s63, s62
    s_lshl_b32 s63, s63, 11
    s_add_u32 s63, s63, 49152
    v_add_u32 v188, s63, v1
    s_add_u32 s63, s61, s62
    s_lshl_b32 s63, s63, 11
    v_add_u32 v189, s63, v1
    v_add_u32 v190, 131072, v189
    v_and_b32 v6, 31, v0
    v_lshrrev_b32 v7, 5, v0
    v_lshlrev_b32 v7, 4, v7
    v_lshl_add_u32 v191, v6, 10, v7
    s_setpc_b64 s[44:45]
L_w6:
    v_lshrrev_b32 v6, 4, v0
    v_and_b32 v7, 7, v0
    v_xor_b32 v7, v7, v6
    v_lshlrev_b32 v7, 4, v7
    v_lshrrev_b32 v8, 3, v0
    v_lshl_add_u32 v112, v8, 10, v7
    v_xor_b32 v113, 64, v112
    v_add_u32 v113, 7168, v113
    v_add_u32 v114, 14336, v112
    v_add_u32 v115, 14336, v113
    v_lshrrev_b32 v7, 2, v0
    v_xor_b32 v6, v6, v7
    v_and_b32 v6, 1, v6
    v_lshlrev_b32 v6, 6, v6
    v_and_b32 v7, 3, v0
    v_lshl_add_u32 v6, v7, 4, v6
    v_lshl_add_u32 v116, v8, 10, v6
    v_mul_u32_u24 v8, 3072, v8
    v_add_u32 v120, v8, v6
    v_add_u32 v117, 7168, v116
    v_add_u32 v121, 23552, v120
    v_add_u32 v118, 14336, v116
    v_add_u32 v122, 47104, v120
    v_add_u32 v119, 21504, v116
    v_add_u32 v123, 70656, v120
    s_lshl_b32 s60, s53, 16
    s_lshl_b32 s65, s54, 7
    s_barrier
    s_add_u32 s64, s3, 0
    s_and_b32 s64, s64, 7
    s_lshl_b32 s61, s64, 7
    s_add_u32 s61, s61, s60
    s_lshl_b32 s62, s64, 16
    s_add_u32 s62, s62, s65
    s_mul_i32 s63, s64, 196608
    s_add_u32 s63, s63, s65
    s_mov_b32 m0, 0
    s_add_u32 s64, s61, 0
    buffer_load_dwordx4 v112, s[8:11], s64 offen offset:0 lds
    buffer_load_dwordx4 v113, s[8:11], s64 offen offset:1024 lds
    buffer_load_dwordx4 v114, s[8:11], s64 offen offset:2048 lds
    buffer_load_dwordx4 v115, s[8:11], s64 offen offset:3072 lds
    s_mov_b32 m0, 4096
    s_add_u32 s64, s61, 32768
    buffer_load_dwordx4 v112, s[8:11], s64 offen offset:0 lds
    buffer_load_dwordx4 v113, s[8:11], s64 offen offset:1024 lds
    buffer_load_dwordx4 v114, s[8:11], s64 offen offset:2048 lds
    buffer_load_dwordx4 v115, s[8:11], s64 offen offset:3072 lds
    s_mov_b32 m0, 8192
    s_add_u32 s64, s62, 0
    buffer_load_dwordx4 v116, s[16:19], s64 offen offset:0 lds
    buffer_load_dwordx4 v117, s[16:19], s64 offen offset:1024 lds
    buffer_load_dwordx4 v118, s[16:19], s64 offen offset:2048 lds
    buffer_load_dwordx4 v119, s[16:19], s64 offen offset:3072 lds
    s_mov_b32 m0, 12288
    s_add_u32 s64, s62, 32768
    buffer_load_dwordx4 v116, s[16:19], s64 offen offset:0 lds
    buffer_load_dwordx4 v117, s[16:19], s64 offen offset:1024 lds
    buffer_load_dwordx4 v118, s[16:19], s64 offen offset:2048 lds
    buffer_load_dwordx4 v119, s[16:19], s64 offen offset:3072 lds
    s_mov_b32 m0, 16384
    s_add_u32 s64, s63, 0
    buffer_load_dwordx4 v120, s[12:15], s64 offen offset:0 lds
    buffer_load_dwordx4 v121, s[12:15], s64 offen offset:1024 lds
    buffer_load_dwordx4 v122, s[12:15], s64 offen offset:2048 lds
    buffer_load_dwordx4 v123, s[12:15], s64 offen offset:3072 lds
    s_add_u32 s64, s3, 1
    s_and_b32 s64, s64, 7
    s_lshl_b32 s61, s64, 7
    s_add_u32 s61, s61, s60
    s_lshl_b32 s62, s64, 16
    s_add_u32 s62, s62, s65
    s_mul_i32 s63, s64, 196608
    s_add_u32 s63, s63, s65
    s_mov_b32 m0, 40960
    s_add_u32 s64, s61, 0
    buffer_load_dwordx4 v112, s[8:11], s64 offen offset:0 lds
    buffer_load_dwordx4 v113, s[8:11], s64 offen offset:1024 lds
    buffer_load_dwordx4 v114, s[8:11], s64 offen offset:2048 lds
    buffer_load_dwordx4 v115, s[8:11], s64 offen offset:3072 lds
    s_mov_b32 m0, 45056
    s_add_u32 s64, s61, 32768
    buffer_load_dwordx4 v112, s[8:11], s64 offen offset:0 lds
    buffer_load_dwordx4 v113, s[8:11], s64 offen offset:1024 lds
    buffer_load_dwordx4 v114, s[8:11], s64 offen offset:2048 lds
    buffer_load_dwordx4 v115, s[8:11], s64 offen offset:3072 lds
    s_mov_b32 m0, 49152
    s_add_u32 s64, s62, 0
    buffer_load_dwordx4 v116, s[16:19], s64 offen offset:0 lds
    buffer_load_dwordx4 v117, s[16:19], s64 offen offset:1024 lds
    buffer_load_dwordx4 v118, s[16:19], s64 offen offset:2048 lds
    buffer_load_dwordx4 v119, s[16:19], s64 offen offset:3072 lds
    s_mov_b32 m0, 53248
    s_add_u32 s64, s62, 32768
    buffer_load_dwordx4 v116, s[16:19], s64 offen offset:0 lds
    buffer_load_dwordx4 v117, s[16:19], s64 offen offset:1024 lds
    buffer_load_dwordx4 v118, s[16:19], s64 offen offset:2048 lds
    buffer_load_dwordx4 v119, s[16:19], s64 offen offset:3072 lds
    s_mov_b32 m0, 57344
    s_add_u32 s64, s63, 0
    buffer_load_dwordx4 v120, s[12:15], s64 offen offset:0 lds
    buffer_load_dwordx4 v121, s[12:15], s64 offen offset:1024 lds
    buffer_load_dwordx4 v122, s[12:15], s64 offen offset:2048 lds
    buffer_load_dwordx4 v123, s[12:15], s64 offen offset:3072 lds
    s_waitcnt vmcnt(20)
    s_barrier
    s_add_u32 s64, s3, 2
    s_and_b32 s64, s64, 7
    s_lshl_b32 s61, s64, 7
    s_add_u32 s61, s61, s60
    s_lshl_b32 s62, s64, 16
    s_add_u32 s62, s62, s65
    s_mul_i32 s63, s64, 196608
    s_add_u32 s63, s63, s65
    s_mov_b32 m0, 81920
    s_add_u32 s64, s61, 0
    buffer_load_dwordx4 v112, s[8:11], s64 offen offset:0 lds
    buffer_load_dwordx4 v113, s[8:11], s64 offen offset:1024 lds
    buffer_load_dwordx4 v114, s[8:11], s64 offen offset:2048 lds
    buffer_load_dwordx4 v115, s[8:11], s64 offen offset:3072 lds
    s_mov_b32 m0, 86016
    s_add_u32 s64, s61, 32768
    buffer_load_dwordx4 v112, s[8:11], s64 offen offset:0 lds
    buffer_load_dwordx4 v113, s[8:11], s64 offen offset:1024 lds
    buffer_load_dwordx4 v114, s[8:11], s64 offen offset:2048 lds
    buffer_load_dwordx4 v115, s[8:11], s64 offen offset:3072 lds
    s_mov_b32 m0, 90112
    s_add_u32 s64, s62, 0
    buffer_load_dwordx4 v116, s[16:19], s64 offen offset:0 lds
    buffer_load_dwordx4 v117, s[16:19], s64 offen offset:1024 lds
    buffer_load_dwordx4 v118, s[16:19], s64 offen offset:2048 lds
    buffer_load_dwordx4 v119, s[16:19], s64 offen offset:3072 lds
    s_mov_b32 m0, 94208
    s_add_u32 s64, s62, 32768
    buffer_load_dwordx4 v116, s[16:19], s64 offen offset:0 lds
    buffer_load_dwordx4 v117, s[16:19], s64 offen offset:1024 lds
    buffer_load_dwordx4 v118, s[16:19], s64 offen offset:2048 lds
    buffer_load_dwordx4 v119, s[16:19], s64 offen offset:3072 lds
    s_mov_b32 m0, 98304
    s_add_u32 s64, s63, 0
    buffer_load_dwordx4 v120, s[12:15], s64 offen offset:0 lds
    buffer_load_dwordx4 v121, s[12:15], s64 offen offset:1024 lds
    buffer_load_dwordx4 v122, s[12:15], s64 offen offset:2048 lds
    buffer_load_dwordx4 v123, s[12:15], s64 offen offset:3072 lds
    s_add_u32 s64, s3, 3
    s_and_b32 s64, s64, 7
    s_lshl_b32 s61, s64, 7
    s_add_u32 s61, s61, s60
    s_lshl_b32 s62, s64, 16
    s_add_u32 s62, s62, s65
    s_mul_i32 s63, s64, 196608
    s_add_u32 s63, s63, s65
    s_mov_b32 m0, 122880
    s_add_u32 s64, s61, 0
    buffer_load_dwordx4 v112, s[8:11], s64 offen offset:0 lds
    buffer_load_dwordx4 v113, s[8:11], s64 offen offset:1024 lds
    buffer_load_dwordx4 v114, s[8:11], s64 offen offset:2048 lds
    buffer_load_dwordx4 v115, s[8:11], s64 offen offset:3072 lds
    s_mov_b32 m0, 126976
    s_add_u32 s64, s61, 32768
    buffer_load_dwordx4 v112, s[8:11], s64 offen offset:0 lds
    buffer_load_dwordx4 v113, s[8:11], s64 offen offset:1024 lds
    buffer_load_dwordx4 v114, s[8:11], s64 offen offset:2048 lds
    buffer_load_dwordx4 v115, s[8:11], s64 offen offset:3072 lds
    s_waitcnt vmcnt(28)
    s_barrier
    s_mov_b32 m0, 131072
    s_add_u32 s64, s62, 0
    buffer_load_dwordx4 v116, s[16:19], s64 offen offset:0 lds
    buffer_load_dwordx4 v117, s[16:19], s64 offen offset:1024 lds
    buffer_load_dwordx4 v118, s[16:19], s64 offen offset:2048 lds
    buffer_load_dwordx4 v119, s[16:19], s64 offen offset:3072 lds
    s_mov_b32 m0, 135168
    s_add_u32 s64, s62, 32768
    buffer_load_dwordx4 v116, s[16:19], s64 offen offset:0 lds
    buffer_load_dwordx4 v117, s[16:19], s64 offen offset:1024 lds
    buffer_load_dwordx4 v118, s[16:19], s64 offen offset:2048 lds
    buffer_load_dwordx4 v119, s[16:19], s64 offen offset:3072 lds
    s_mov_b32 m0, 139264
    s_add_u32 s64, s63, 0
    buffer_load_dwordx4 v120, s[12:15], s64 offen offset:0 lds
    buffer_load_dwordx4 v121, s[12:15], s64 offen offset:1024 lds
    buffer_load_dwordx4 v122, s[12:15], s64 offen offset:2048 lds
    buffer_load_dwordx4 v123, s[12:15], s64 offen offset:3072 lds
    s_add_u32 s64, s3, 4
    s_and_b32 s64, s64, 7
    s_lshl_b32 s61, s64, 7
    s_add_u32 s61, s61, s60
    s_lshl_b32 s62, s64, 16
    s_add_u32 s62, s62, s65
    s_mul_i32 s63, s64, 196608
    s_add_u32 s63, s63, s65
    s_mov_b32 m0, 0
    s_add_u32 s64, s61, 0
    buffer_load_dwordx4 v112, s[8:11], s64 offen offset:0 lds
    buffer_load_dwordx4 v113, s[8:11], s64 offen offset:1024 lds
    buffer_load_dwordx4 v114, s[8:11], s64 offen offset:2048 lds
    buffer_load_dwordx4 v115, s[8:11], s64 offen offset:3072 lds
    s_mov_b32 m0, 4096
    s_add_u32 s64, s61, 32768
    buffer_load_dwordx4 v112, s[8:11], s64 offen offset:0 lds
    buffer_load_dwordx4 v113, s[8:11], s64 offen offset:1024 lds
    buffer_load_dwordx4 v114, s[8:11], s64 offen offset:2048 lds
    buffer_load_dwordx4 v115, s[8:11], s64 offen offset:3072 lds
    s_waitcnt vmcnt(28)
    s_barrier
    s_mov_b32 m0, 8192
    s_add_u32 s64, s62, 0
    buffer_load_dwordx4 v116, s[16:19], s64 offen offset:0 lds
    buffer_load_dwordx4 v117, s[16:19], s64 offen offset:1024 lds
    buffer_load_dwordx4 v118, s[16:19], s64 offen offset:2048 lds
    buffer_load_dwordx4 v119, s[16:19], s64 offen offset:3072 lds
    s_mov_b32 m0, 12288
    s_add_u32 s64, s62, 32768
    buffer_load_dwordx4 v116, s[16:19], s64 offen offset:0 lds
    buffer_load_dwordx4 v117, s[16:19], s64 offen offset:1024 lds
    buffer_load_dwordx4 v118, s[16:19], s64 offen offset:2048 lds
    buffer_load_dwordx4 v119, s[16:19], s64 offen offset:3072 lds
    s_mov_b32 m0, 16384
    s_add_u32 s64, s63, 0
    buffer_load_dwordx4 v120, s[12:15], s64 offen offset:0 lds
    buffer_load_dwordx4 v121, s[12:15], s64 offen offset:1024 lds
    buffer_load_dwordx4 v122, s[12:15], s64 offen offset:2048 lds
    buffer_load_dwordx4 v123, s[12:15], s64 offen offset:3072 lds
    s_add_u32 s64, s3, 5
    s_and_b32 s64, s64, 7
    s_lshl_b32 s61, s64, 7
    s_add_u32 s61, s61, s60
    s_lshl_b32 s62, s64, 16
    s_add_u32 s62, s62, s65
    s_mul_i32 s63, s64, 196608
    s_add_u32 s63, s63, s65
    s_mov_b32 m0, 40960
    s_add_u32 s64, s61, 0
    buffer_load_dwordx4 v112, s[8:11], s64 offen offset:0 lds
    buffer_load_dwordx4 v113, s[8:11], s64 offen offset:1024 lds
    buffer_load_dwordx4 v114, s[8:11], s64 offen offset:2048 lds
    buffer_load_dwordx4 v115, s[8:11], s64 offen offset:3072 lds
    s_mov_b32 m0, 45056
    s_add_u32 s64, s61, 32768
    buffer_load_dwordx4 v112, s[8:11], s64 offen offset:0 lds
    buffer_load_dwordx4 v113, s[8:11], s64 offen offset:1024 lds
    buffer_load_dwordx4 v114, s[8:11], s64 offen offset:2048 lds
    buffer_load_dwordx4 v115, s[8:11], s64 offen offset:3072 lds
    s_waitcnt vmcnt(28)
    s_barrier
    s_mov_b32 m0, 49152
    s_add_u32 s64, s62, 0
    buffer_load_dwordx4 v116, s[16:19], s64 offen offset:0 lds
    buffer_load_dwordx4 v117, s[16:19], s64 offen offset:1024 lds
    buffer_load_dwordx4 v118, s[16:19], s64 offen offset:2048 lds
    buffer_load_dwordx4 v119, s[16:19], s64 offen offset:3072 lds
    s_mov_b32 m0, 53248
    s_add_u32 s64, s62, 32768
    buffer_load_dwordx4 v116, s[16:19], s64 offen offset:0 lds
    buffer_load_dwordx4 v117, s[16:19], s64 offen offset:1024 lds
    buffer_load_dwordx4 v118, s[16:19], s64 offen offset:2048 lds
    buffer_load_dwordx4 v119, s[16:19], s64 offen offset:3072 lds
    s_mov_b32 m0, 57344
    s_add_u32 s64, s63, 0
    buffer_load_dwordx4 v120, s[12:15], s64 offen offset:0 lds
    buffer_load_dwordx4 v121, s[12:15], s64 offen offset:1024 lds
    buffer_load_dwordx4 v122, s[12:15], s64 offen offset:2048 lds
    buffer_load_dwordx4 v123, s[12:15], s64 offen offset:3072 lds
    s_add_u32 s64, s3, 6
    s_and_b32 s64, s64, 7
    s_lshl_b32 s61, s64, 7
    s_add_u32 s61, s61, s60
    s_lshl_b32 s62, s64, 16
    s_add_u32 s62, s62, s65
    s_mul_i32 s63, s64, 196608
    s_add_u32 s63, s63, s65
    s_mov_b32 m0, 81920
    s_add_u32 s64, s61, 0
    buffer_load_dwordx4 v112, s[8:11], s64 offen offset:0 lds
    buffer_load_dwordx4 v113, s[8:11], s64 offen offset:1024 lds
    buffer_load_dwordx4 v114, s[8:11], s64 offen offset:2048 lds
    buffer_load_dwordx4 v115, s[8:11], s64 offen offset:3072 lds
    s_mov_b32 m0, 86016
    s_add_u32 s64, s61, 32768
    buffer_load_dwordx4 v112, s[8:11], s64 offen offset:0 lds
    buffer_load_dwordx4 v113, s[8:11], s64 offen offset:1024 lds
    buffer_load_dwordx4 v114, s[8:11], s64 offen offset:2048 lds
    buffer_load_dwordx4 v115, s[8:11], s64 offen offset:3072 lds
    s_waitcnt vmcnt(28)
    s_barrier
    s_mov_b32 m0, 90112
    s_add_u32 s64, s62, 0
    buffer_load_dwordx4 v116, s[16:19], s64 offen offset:0 lds
    buffer_load_dwordx4 v117, s[16:19], s64 offen offset:1024 lds
    buffer_load_dwordx4 v118, s[16:19], s64 offen offset:2048 lds
    buffer_load_dwordx4 v119, s[16:19], s64 offen offset:3072 lds
    s_mov_b32 m0, 94208
    s_add_u32 s64, s62, 32768
    buffer_load_dwordx4 v116, s[16:19], s64 offen offset:0 lds
    buffer_load_dwordx4 v117, s[16:19], s64 offen offset:1024 lds
    buffer_load_dwordx4 v118, s[16:19], s64 offen offset:2048 lds
    buffer_load_dwordx4 v119, s[16:19], s64 offen offset:3072 lds
    s_mov_b32 m0, 98304
    s_add_u32 s64, s63, 0
    buffer_load_dwordx4 v120, s[12:15], s64 offen offset:0 lds
    buffer_load_dwordx4 v121, s[12:15], s64 offen offset:1024 lds
    buffer_load_dwordx4 v122, s[12:15], s64 offen offset:2048 lds
    buffer_load_dwordx4 v123, s[12:15], s64 offen offset:3072 lds
    s_add_u32 s64, s3, 7
    s_and_b32 s64, s64, 7
    s_lshl_b32 s61, s64, 7
    s_add_u32 s61, s61, s60
    s_lshl_b32 s62, s64, 16
    s_add_u32 s62, s62, s65
    s_mul_i32 s63, s64, 196608
    s_add_u32 s63, s63, s65
    s_mov_b32 m0, 122880
    s_add_u32 s64, s61, 0
    buffer_load_dwordx4 v112, s[8:11], s64 offen offset:0 lds
    buffer_load_dwordx4 v113, s[8:11], s64 offen offset:1024 lds
    buffer_load_dwordx4 v114, s[8:11], s64 offen offset:2048 lds
    buffer_load_dwordx4 v115, s[8:11], s64 offen offset:3072 lds
    s_mov_b32 m0, 126976
    s_add_u32 s64, s61, 32768
    buffer_load_dwordx4 v112, s[8:11], s64 offen offset:0 lds
    buffer_load_dwordx4 v113, s[8:11], s64 offen offset:1024 lds
    buffer_load_dwordx4 v114, s[8:11], s64 offen offset:2048 lds
    buffer_load_dwordx4 v115, s[8:11], s64 offen offset:3072 lds
    s_waitcnt vmcnt(28)
    s_barrier
    s_mov_b32 m0, 131072
    s_add_u32 s64, s62, 0
    buffer_load_dwordx4 v116, s[16:19], s64 offen offset:0 lds
    buffer_load_dwordx4 v117, s[16:19], s64 offen offset:1024 lds
    buffer_load_dwordx4 v118, s[16:19], s64 offen offset:2048 lds
    buffer_load_dwordx4 v119, s[16:19], s64 offen offset:3072 lds
    s_mov_b32 m0, 135168
    s_add_u32 s64, s62, 32768
    buffer_load_dwordx4 v116, s[16:19], s64 offen offset:0 lds
    buffer_load_dwordx4 v117, s[16:19], s64 offen offset:1024 lds
    buffer_load_dwordx4 v118, s[16:19], s64 offen offset:2048 lds
    buffer_load_dwordx4 v119, s[16:19], s64 offen offset:3072 lds
    s_mov_b32 m0, 139264
    s_add_u32 s64, s63, 0
    buffer_load_dwordx4 v120, s[12:15], s64 offen offset:0 lds
    buffer_load_dwordx4 v121, s[12:15], s64 offen offset:1024 lds
    buffer_load_dwordx4 v122, s[12:15], s64 offen offset:2048 lds
    buffer_load_dwordx4 v123, s[12:15], s64 offen offset:3072 lds
    s_waitcnt vmcnt(20)
    s_barrier
    s_call_b64 s[44:45], L_setup1
    s_waitcnt vmcnt(0)
    s_barrier
    s_call_b64 s[44:45], L_setup2
    s_branch L_kvb
L_g1:
    s_barrier
    s_call_b64 s[44:45], L_setup1
    s_call_b64 s[44:45], L_setup2
    v_and_b32 v6, 31, v0
    v_lshrrev_b32 v7, 5, v0
    v_bfe_u32 v8, v0, 1, 3
    v_xor_b32 v7, v7, v8
    v_lshlrev_b32 v7, 4, v7
    v_lshl_add_u32 v16, v6, 7, v7
    v_xor_b32 v17, 32, v16
    v_xor_b32 v18, 64, v16
    v_xor_b32 v19, 96, v16
    v_add_u32 v20, 81920, v16
    v_add_u32 v21, 81920, v17
    v_add_u32 v22, 81920, v18
    v_add_u32 v23, 81920, v19
    v_bfe_u32 v6, v0, 2, 2
    v_lshrrev_b32 v7, 5, v0
    v_lshl_add_u32 v7, v7, 3, v6
    v_lshrrev_b32 v6, 1, v6
    v_lshlrev_b32 v6, 6, v6
    v_lshl_add_u32 v6, v7, 7, v6
    v_bfe_u32 v7, v0, 4, 1
    v_lshl_add_u32 v6, v7, 5, v6
    v_and_b32 v7, 3, v0
    v_lshl_add_u32 v6, v7, 3, v6
    s_and_b32 s60, s52, 1
    s_lshl_b32 s61, s60, 6
    v_xor_b32 v24, s61, v6
    v_add_u32 v24, 24576, v24
    v_add_u32 v25, 81920, v24
    s_lshl_b32 s62, s54, 1
    s_add_u32 s62, s62, s60
    s_lshl_b32 s62, s62, 7
    s_lshl_b32 s61, s53, 1
    s_add_u32 s6, s62, s61
    v_and_b32 v9, 31, v0
    v_and_b32 v176, 0x13, v9
    v_and_b32 v7, 4, v9
    v_lshl_or_b32 v176, v7, 1, v176
    v_and_b32 v7, 8, v9
    v_lshrrev_b32 v7, 1, v7
    v_or_b32 v176, v176, v7
    v_and_b32 v6, 32, v0
    v_add_u32 v176, v176, v6
    v_lshlrev_b32 v176, 4, v176
    v_and_b32 v6, 15, v0
    v_lshrrev_b32 v7, 5, v0
    v_lshl_add_u32 v7, v7, 4, v6
    v_lshlrev_b32 v7, 4, v7
    v_bfe_u32 v6, v0, 4, 1
    v_lshl_add_u32 v177, v6, 17, v7
    s_lshl_b32 s6, s6, 11
    s_add_u32 s6, s6, 4194304
    s_mov_b32 s16, s42
    s_mov_b32 s17, s43
    s_mov_b32 s18, 524288
    s_mov_b32 s19, 0x00020000
    s_mov_b32 s12, s48
    s_mov_b32 s13, s49
    s_mov_b32 s14, 524288
    s_mov_b32 s15, 0x00020000
    s_mov_b32 s8, s46
    s_mov_b32 s9, s47
    s_mov_b32 s10, 2097152
    s_mov_b32 s11, 0x00020000
    s_add_u32 s20, s50, 8388608
    s_addc_u32 s21, s51, 0
    s_mov_b32 s22, 131072
    s_mov_b32 s23, 0x00020000
    s_waitcnt lgkmcnt(0)
    s_add_u32 s55, s55, 1
    s_barrier
    ds_read_b128 v[32:35], v16 offset:0
    ds_read_b128 v[36:39], v16 offset:4096
    ds_read_b64_tr_b16 v[48:49], v24 offset:0
    ds_read_b64_tr_b16 v[50:51], v24 offset:512
    ds_read_b64_tr_b16 v[52:53], v24 offset:8192
    ds_read_b64_tr_b16 v[54:55], v24 offset:8704
    ds_read_b128 v[40:43], v17 offset:0
    ds_read_b128 v[44:47], v17 offset:4096
    s_waitcnt lgkmcnt(2)
    v_mfma_f32_32x32x16_bf16 v[112:127], v[48:51], v[32:35], 0
    ds_read_b64_tr_b16 v[56:57], v24 offset:2048
    ds_read_b64_tr_b16 v[58:59], v24 offset:2560
    v_mfma_f32_32x32x16_bf16 v[128:143], v[32:35], v[52:55], 0
    ds_read_b64_tr_b16 v[60:61], v24 offset:10240
    ds_read_b64_tr_b16 v[62:63], v24 offset:10752
    v_mfma_f32_32x32x16_bf16 v[144:159], v[48:51], v[36:39], 0
    v_mfma_f32_32x32x16_bf16 v[160:175], v[36:39], v[52:55], 0
    ds_read_b128 v[32:35], v18 offset:0
    ds_read_b128 v[36:39], v18 offset:4096
    s_waitcnt lgkmcnt(2)
    v_mfma_f32_32x32x16_bf16 v[112:127], v[56:59], v[40:43], v[112:127]
    ds_read_b64_tr_b16 v[48:49], v24 offset:4096
    ds_read_b64_tr_b16 v[50:51], v24 offset:4608
    v_mfma_f32_32x32x16_bf16 v[128:143], v[40:43], v[60:63], v[128:143]
    ds_read_b64_tr_b16 v[52:53], v24 offset:12288
    ds_read_b64_tr_b16 v[54:55], v24 offset:12800
    v_mfma_f32_32x32x16_bf16 v[144:159], v[56:59], v[44:47], v[144:159]
    v_mfma_f32_32x32x16_bf16 v[160:175], v[44:47], v[60:63], v[160:175]
    ds_read_b128 v[40:43], v19 offset:0
    ds_read_b128 v[44:47], v19 offset:4096
    s_waitcnt lgkmcnt(2)
    v_mfma_f32_32x32x16_bf16 v[112:127], v[48:51], v[32:35], v[112:127]
    ds_read_b64_tr_b16 v[56:57], v24 offset:6144
    ds_read_b64_tr_b16 v[58:59], v24 offset:6656
    v_mfma_f32_32x32x16_bf16 v[128:143], v[32:35], v[52:55], v[128:143]
    ds_read_b64_tr_b16 v[60:61], v24 offset:14336
    ds_read_b64_tr_b16 v[62:63], v24 offset:14848
    v_mfma_f32_32x32x16_bf16 v[144:159], v[48:51], v[36:39], v[144:159]
    v_mfma_f32_32x32x16_bf16 v[160:175], v[36:39], v[52:55], v[160:175]
    s_waitcnt lgkmcnt(0)
    s_barrier
    v_mfma_f32_32x32x16_bf16 v[112:127], v[56:59], v[40:43], v[112:127]
    ds_read_b128 v[32:35], v16 offset:40960
    ds_read_b128 v[36:39], v16 offset:45056
    v_mfma_f32_32x32x16_bf16 v[128:143], v[40:43], v[60:63], v[128:143]
    ds_read_b64_tr_b16 v[48:49], v24 offset:40960
    ds_read_b64_tr_b16 v[50:51], v24 offset:41472
    v_mfma_f32_32x32x16_bf16 v[144:159], v[56:59], v[44:47], v[144:159]
    ds_read_b64_tr_b16 v[52:53], v24 offset:49152
    ds_read_b64_tr_b16 v[54:55], v24 offset:49664
    v_mfma_f32_32x32x16_bf16 v[160:175], v[44:47], v[60:63], v[160:175]
    ds_read_b128 v[40:43], v17 offset:40960
    ds_read_b128 v[44:47], v17 offset:45056
    s_waitcnt lgkmcnt(2)
    v_mfma_f32_32x32x16_bf16 v[112:127], v[48:51], v[32:35], v[112:127]
    ds_read_b64_tr_b16 v[56:57], v24 offset:43008
    ds_read_b64_tr_b16 v[58:59], v24 offset:43520
    v_mfma_f32_32x32x16_bf16 v[128:143], v[32:35], v[52:55], v[128:143]
    ds_read_b64_tr_b16 v[60:61], v24 offset:51200
    ds_read_b64_tr_b16 v[62:63], v24 offset:51712
    v_mfma_f32_32x32x16_bf16 v[144:159], v[48:51], v[36:39], v[144:159]
    v_mfma_f32_32x32x16_bf16 v[160:175], v[36:39], v[52:55], v[160:175]
    ds_read_b128 v[32:35], v18 offset:40960
    ds_read_b128 v[36:39], v18 offset:45056
    s_waitcnt lgkmcnt(2)
    v_mfma_f32_32x32x16_bf16 v[112:127], v[56:59], v[40:43], v[112:127]
    ds_read_b64_tr_b16 v[48:49], v24 offset:45056
    ds_read_b64_tr_b16 v[50:51], v24 offset:45568
    v_mfma_f32_32x32x16_bf16 v[128:143], v[40:43], v[60:63], v[128:143]
    ds_read_b64_tr_b16 v[52:53], v24 offset:53248
    ds_read_b64_tr_b16 v[54:55], v24 offset:53760
    v_mfma_f32_32x32x16_bf16 v[144:159], v[56:59], v[44:47], v[144:159]
    v_mfma_f32_32x32x16_bf16 v[160:175], v[44:47], v[60:63], v[160:175]
    ds_read_b128 v[40:43], v19 offset:40960
    ds_read_b128 v[44:47], v19 offset:45056
    s_waitcnt lgkmcnt(2)
    v_mfma_f32_32x32x16_bf16 v[112:127], v[48:51], v[32:35], v[112:127]
    ds_read_b64_tr_b16 v[56:57], v24 offset:47104
    ds_read_b64_tr_b16 v[58:59], v24 offset:47616
    v_mfma_f32_32x32x16_bf16 v[128:143], v[32:35], v[52:55], v[128:143]
    ds_read_b64_tr_b16 v[60:61], v24 offset:55296
    ds_read_b64_tr_b16 v[62:63], v24 offset:55808
    v_mfma_f32_32x32x16_bf16 v[144:159], v[48:51], v[36:39], v[144:159]
    v_mfma_f32_32x32x16_bf16 v[160:175], v[36:39], v[52:55], v[160:175]
    s_waitcnt lgkmcnt(0)
    s_barrier
    v_mfma_f32_32x32x16_bf16 v[112:127], v[56:59], v[40:43], v[112:127]
    ds_read_b128 v[32:35], v20 offset:0
    ds_read_b128 v[36:39], v20 offset:4096
    v_mfma_f32_32x32x16_bf16 v[128:143], v[40:43], v[60:63], v[128:143]
    ds_read_b64_tr_b16 v[48:49], v25 offset:0
    ds_read_b64_tr_b16 v[50:51], v25 offset:512
    v_mfma_f32_32x32x16_bf16 v[144:159], v[56:59], v[44:47], v[144:159]
    ds_read_b64_tr_b16 v[52:53], v25 offset:8192
    ds_read_b64_tr_b16 v[54:55], v25 offset:8704
    v_mfma_f32_32x32x16_bf16 v[160:175], v[44:47], v[60:63], v[160:175]
    ds_read_b128 v[40:43], v21 offset:0
    ds_read_b128 v[44:47], v21 offset:4096
    s_waitcnt lgkmcnt(2)
    v_mfma_f32_32x32x16_bf16 v[112:127], v[48:51], v[32:35], v[112:127]
    ds_read_b64_tr_b16 v[56:57], v25 offset:2048
    ds_read_b64_tr_b16 v[58:59], v25 offset:2560
    v_mfma_f32_32x32x16_bf16 v[128:143], v[32:35], v[52:55], v[128:143]
    ds_read_b64_tr_b16 v[60:61], v25 offset:10240
    ds_read_b64_tr_b16 v[62:63], v25 offset:10752
    v_mfma_f32_32x32x16_bf16 v[144:159], v[48:51], v[36:39], v[144:159]
    v_mfma_f32_32x32x16_bf16 v[160:175], v[36:39], v[52:55], v[160:175]
    ds_read_b128 v[32:35], v22 offset:0
    ds_read_b128 v[36:39], v22 offset:4096
    s_waitcnt lgkmcnt(2)
    v_mfma_f32_32x32x16_bf16 v[112:127], v[56:59], v[40:43], v[112:127]
    ds_read_b64_tr_b16 v[48:49], v25 offset:4096
    ds_read_b64_tr_b16 v[50:51], v25 offset:4608
    v_mfma_f32_32x32x16_bf16 v[128:143], v[40:43], v[60:63], v[128:143]
    ds_read_b64_tr_b16 v[52:53], v25 offset:12288
    ds_read_b64_tr_b16 v[54:55], v25 offset:12800
    v_mfma_f32_32x32x16_bf16 v[144:159], v[56:59], v[44:47], v[144:159]
    v_mfma_f32_32x32x16_bf16 v[160:175], v[44:47], v[60:63], v[160:175]
    ds_read_b128 v[40:43], v23 offset:0
    ds_read_b128 v[44:47], v23 offset:4096
    s_waitcnt lgkmcnt(2)
    v_mfma_f32_32x32x16_bf16 v[112:127], v[48:51], v[32:35], v[112:127]
    ds_read_b64_tr_b16 v[56:57], v25 offset:6144
    ds_read_b64_tr_b16 v[58:59], v25 offset:6656
    v_mfma_f32_32x32x16_bf16 v[128:143], v[32:35], v[52:55], v[128:143]
    ds_read_b64_tr_b16 v[60:61], v25 offset:14336
    ds_read_b64_tr_b16 v[62:63], v25 offset:14848
    v_mfma_f32_32x32x16_bf16 v[144:159], v[48:51], v[36:39], v[144:159]
    v_mfma_f32_32x32x16_bf16 v[160:175], v[36:39], v[52:55], v[160:175]
    s_waitcnt lgkmcnt(0)
    s_barrier
    v_mfma_f32_32x32x16_bf16 v[112:127], v[56:59], v[40:43], v[112:127]
    ds_read_b128 v[32:35], v20 offset:40960
    ds_read_b128 v[36:39], v20 offset:45056
    v_mfma_f32_32x32x16_bf16 v[128:143], v[40:43], v[60:63], v[128:143]
    ds_read_b64_tr_b16 v[48:49], v25 offset:40960
    ds_read_b64_tr_b16 v[50:51], v25 offset:41472
    v_mfma_f32_32x32x16_bf16 v[144:159], v[56:59], v[44:47], v[144:159]
    ds_read_b64_tr_b16 v[52:53], v25 offset:49152
    ds_read_b64_tr_b16 v[54:55], v25 offset:49664
    v_mfma_f32_32x32x16_bf16 v[160:175], v[44:47], v[60:63], v[160:175]
    ds_read_b128 v[40:43], v21 offset:40960
    ds_read_b128 v[44:47], v21 offset:45056
    s_waitcnt lgkmcnt(2)
    v_mfma_f32_32x32x16_bf16 v[112:127], v[48:51], v[32:35], v[112:127]
    ds_read_b64_tr_b16 v[56:57], v25 offset:43008
    ds_read_b64_tr_b16 v[58:59], v25 offset:43520
    v_mfma_f32_32x32x16_bf16 v[128:143], v[32:35], v[52:55], v[128:143]
    ds_read_b64_tr_b16 v[60:61], v25 offset:51200
    ds_read_b64_tr_b16 v[62:63], v25 offset:51712
    v_mfma_f32_32x32x16_bf16 v[144:159], v[48:51], v[36:39], v[144:159]
    v_mfma_f32_32x32x16_bf16 v[160:175], v[36:39], v[52:55], v[160:175]
    ds_read_b128 v[32:35], v22 offset:40960
    ds_read_b128 v[36:39], v22 offset:45056
    s_waitcnt lgkmcnt(2)
    v_mfma_f32_32x32x16_bf16 v[112:127], v[56:59], v[40:43], v[112:127]
    ds_read_b64_tr_b16 v[48:49], v25 offset:45056
    ds_read_b64_tr_b16 v[50:51], v25 offset:45568
    v_mfma_f32_32x32x16_bf16 v[128:143], v[40:43], v[60:63], v[128:143]
    ds_read_b64_tr_b16 v[52:53], v25 offset:53248
    ds_read_b64_tr_b16 v[54:55], v25 offset:53760
    v_mfma_f32_32x32x16_bf16 v[144:159], v[56:59], v[44:47], v[144:159]
    v_mfma_f32_32x32x16_bf16 v[160:175], v[44:47], v[60:63], v[160:175]
    ds_read_b128 v[40:43], v23 offset:40960
    ds_read_b128 v[44:47], v23 offset:45056
    s_waitcnt lgkmcnt(2)
    v_mfma_f32_32x32x16_bf16 v[112:127], v[48:51], v[32:35], v[112:127]
    ds_read_b64_tr_b16 v[56:57], v25 offset:47104
    ds_read_b64_tr_b16 v[58:59], v25 offset:47616
    v_mfma_f32_32x32x16_bf16 v[128:143], v[32:35], v[52:55], v[128:143]
    ds_read_b64_tr_b16 v[60:61], v25 offset:55296
    ds_read_b64_tr_b16 v[62:63], v25 offset:55808
    v_mfma_f32_32x32x16_bf16 v[144:159], v[48:51], v[36:39], v[144:159]
    v_mfma_f32_32x32x16_bf16 v[160:175], v[36:39], v[52:55], v[160:175]
    s_waitcnt lgkmcnt(0)
    s_barrier
    v_mfma_f32_32x32x16_bf16 v[112:127], v[56:59], v[40:43], v[112:127]
    ds_read_b128 v[32:35], v16 offset:0
    ds_read_b128 v[36:39], v16 offset:4096
    v_mfma_f32_32x32x16_bf16 v[128:143], v[40:43], v[60:63], v[128:143]
    ds_read_b64_tr_b16 v[48:49], v24 offset:0
    ds_read_b64_tr_b16 v[50:51], v24 offset:512
    v_mfma_f32_32x32x16_bf16 v[144:159], v[56:59], v[44:47], v[144:159]
    ds_read_b64_tr_b16 v[52:53], v24 offset:8192
    ds_read_b64_tr_b16 v[54:55], v24 offset:8704
    v_mfma_f32_32x32x16_bf16 v[160:175], v[44:47], v[60:63], v[160:175]
    ds_read_b128 v[40:43], v17 offset:0
    ds_read_b128 v[44:47], v17 offset:4096
    s_waitcnt lgkmcnt(2)
    v_mfma_f32_32x32x16_bf16 v[112:127], v[48:51], v[32:35], v[112:127]
    ds_read_b64_tr_b16 v[56:57], v24 offset:2048
    ds_read_b64_tr_b16 v[58:59], v24 offset:2560
    v_mfma_f32_32x32x16_bf16 v[128:143], v[32:35], v[52:55], v[128:143]
    ds_read_b64_tr_b16 v[60:61], v24 offset:10240
    ds_read_b64_tr_b16 v[62:63], v24 offset:10752
    v_mfma_f32_32x32x16_bf16 v[144:159], v[48:51], v[36:39], v[144:159]
    v_mfma_f32_32x32x16_bf16 v[160:175], v[36:39], v[52:55], v[160:175]
    ds_read_b128 v[32:35], v18 offset:0
    ds_read_b128 v[36:39], v18 offset:4096
    s_waitcnt lgkmcnt(2)
    v_mfma_f32_32x32x16_bf16 v[112:127], v[56:59], v[40:43], v[112:127]
    ds_read_b64_tr_b16 v[48:49], v24 offset:4096
    ds_read_b64_tr_b16 v[50:51], v24 offset:4608
    v_mfma_f32_32x32x16_bf16 v[128:143], v[40:43], v[60:63], v[128:143]
    ds_read_b64_tr_b16 v[52:53], v24 offset:12288
    ds_read_b64_tr_b16 v[54:55], v24 offset:12800
    v_mfma_f32_32x32x16_bf16 v[144:159], v[56:59], v[44:47], v[144:159]
    v_mfma_f32_32x32x16_bf16 v[160:175], v[44:47], v[60:63], v[160:175]
    ds_read_b128 v[40:43], v19 offset:0
    ds_read_b128 v[44:47], v19 offset:4096
    s_waitcnt lgkmcnt(2)
    v_mfma_f32_32x32x16_bf16 v[112:127], v[48:51], v[32:35], v[112:127]
    ds_read_b64_tr_b16 v[56:57], v24 offset:6144
    ds_read_b64_tr_b16 v[58:59], v24 offset:6656
    v_mfma_f32_32x32x16_bf16 v[128:143], v[32:35], v[52:55], v[128:143]
    ds_read_b64_tr_b16 v[60:61], v24 offset:14336
    ds_read_b64_tr_b16 v[62:63], v24 offset:14848
    v_mfma_f32_32x32x16_bf16 v[144:159], v[48:51], v[36:39], v[144:159]
    v_mfma_f32_32x32x16_bf16 v[160:175], v[36:39], v[52:55], v[160:175]
    s_waitcnt lgkmcnt(0)
    s_barrier
    v_mfma_f32_32x32x16_bf16 v[112:127], v[56:59], v[40:43], v[112:127]
    ds_read_b128 v[32:35], v16 offset:40960
    ds_read_b128 v[36:39], v16 offset:45056
    v_mfma_f32_32x32x16_bf16 v[128:143], v[40:43], v[60:63], v[128:143]
    ds_read_b64_tr_b16 v[48:49], v24 offset:40960
    ds_read_b64_tr_b16 v[50:51], v24 offset:41472
    v_mfma_f32_32x32x16_bf16 v[144:159], v[56:59], v[44:47], v[144:159]
    ds_read_b64_tr_b16 v[52:53], v24 offset:49152
    ds_read_b64_tr_b16 v[54:55], v24 offset:49664
    v_mfma_f32_32x32x16_bf16 v[160:175], v[44:47], v[60:63], v[160:175]
    ds_read_b128 v[40:43], v17 offset:40960
    ds_read_b128 v[44:47], v17 offset:45056
    s_waitcnt lgkmcnt(2)
    v_mfma_f32_32x32x16_bf16 v[112:127], v[48:51], v[32:35], v[112:127]
    ds_read_b64_tr_b16 v[56:57], v24 offset:43008
    ds_read_b64_tr_b16 v[58:59], v24 offset:43520
    v_mfma_f32_32x32x16_bf16 v[128:143], v[32:35], v[52:55], v[128:143]
    ds_read_b64_tr_b16 v[60:61], v24 offset:51200
    ds_read_b64_tr_b16 v[62:63], v24 offset:51712
    v_mfma_f32_32x32x16_bf16 v[144:159], v[48:51], v[36:39], v[144:159]
    v_mfma_f32_32x32x16_bf16 v[160:175], v[36:39], v[52:55], v[160:175]
    ds_read_b128 v[32:35], v18 offset:40960
    ds_read_b128 v[36:39], v18 offset:45056
    s_waitcnt lgkmcnt(2)
    v_mfma_f32_32x32x16_bf16 v[112:127], v[56:59], v[40:43], v[112:127]
    ds_read_b64_tr_b16 v[48:49], v24 offset:45056
    ds_read_b64_tr_b16 v[50:51], v24 offset:45568
    v_mfma_f32_32x32x16_bf16 v[128:143], v[40:43], v[60:63], v[128:143]
    ds_read_b64_tr_b16 v[52:53], v24 offset:53248
    ds_read_b64_tr_b16 v[54:55], v24 offset:53760
    v_mfma_f32_32x32x16_bf16 v[144:159], v[56:59], v[44:47], v[144:159]
    v_mfma_f32_32x32x16_bf16 v[160:175], v[44:47], v[60:63], v[160:175]
    ds_read_b128 v[40:43], v19 offset:40960
    ds_read_b128 v[44:47], v19 offset:45056
    s_waitcnt lgkmcnt(2)
    v_mfma_f32_32x32x16_bf16 v[112:127], v[48:51], v[32:35], v[112:127]
    ds_read_b64_tr_b16 v[56:57], v24 offset:47104
    ds_read_b64_tr_b16 v[58:59], v24 offset:47616
    v_mfma_f32_32x32x16_bf16 v[128:143], v[32:35], v[52:55], v[128:143]
    ds_read_b64_tr_b16 v[60:61], v24 offset:55296
    ds_read_b64_tr_b16 v[62:63], v24 offset:55808
    v_mfma_f32_32x32x16_bf16 v[144:159], v[48:51], v[36:39], v[144:159]
    v_mfma_f32_32x32x16_bf16 v[160:175], v[36:39], v[52:55], v[160:175]
    s_waitcnt lgkmcnt(0)
    s_barrier
    v_mfma_f32_32x32x16_bf16 v[112:127], v[56:59], v[40:43], v[112:127]
    ds_read_b128 v[32:35], v20 offset:0
    ds_read_b128 v[36:39], v20 offset:4096
    v_mfma_f32_32x32x16_bf16 v[128:143], v[40:43], v[60:63], v[128:143]
    ds_read_b64_tr_b16 v[48:49], v25 offset:0
    ds_read_b64_tr_b16 v[50:51], v25 offset:512
    v_mfma_f32_32x32x16_bf16 v[144:159], v[56:59], v[44:47], v[144:159]
    ds_read_b64_tr_b16 v[52:53], v25 offset:8192
    ds_read_b64_tr_b16 v[54:55], v25 offset:8704
    v_mfma_f32_32x32x16_bf16 v[160:175], v[44:47], v[60:63], v[160:175]
    ds_read_b128 v[40:43], v21 offset:0
    ds_read_b128 v[44:47], v21 offset:4096
    s_waitcnt lgkmcnt(2)
    v_mfma_f32_32x32x16_bf16 v[112:127], v[48:51], v[32:35], v[112:127]
    ds_read_b64_tr_b16 v[56:57], v25 offset:2048
    ds_read_b64_tr_b16 v[58:59], v25 offset:2560
    v_mfma_f32_32x32x16_bf16 v[128:143], v[32:35], v[52:55], v[128:143]
    ds_read_b64_tr_b16 v[60:61], v25 offset:10240
    ds_read_b64_tr_b16 v[62:63], v25 offset:10752
    v_mfma_f32_32x32x16_bf16 v[144:159], v[48:51], v[36:39], v[144:159]
    v_mfma_f32_32x32x16_bf16 v[160:175], v[36:39], v[52:55], v[160:175]
    ds_read_b128 v[32:35], v22 offset:0
    ds_read_b128 v[36:39], v22 offset:4096
    s_waitcnt lgkmcnt(2)
    v_mfma_f32_32x32x16_bf16 v[112:127], v[56:59], v[40:43], v[112:127]
    ds_read_b64_tr_b16 v[48:49], v25 offset:4096
    ds_read_b64_tr_b16 v[50:51], v25 offset:4608
    v_mfma_f32_32x32x16_bf16 v[128:143], v[40:43], v[60:63], v[128:143]
    ds_read_b64_tr_b16 v[52:53], v25 offset:12288
    ds_read_b64_tr_b16 v[54:55], v25 offset:12800
    v_mfma_f32_32x32x16_bf16 v[144:159], v[56:59], v[44:47], v[144:159]
    v_mfma_f32_32x32x16_bf16 v[160:175], v[44:47], v[60:63], v[160:175]
    ds_read_b128 v[40:43], v23 offset:0
    ds_read_b128 v[44:47], v23 offset:4096
    s_waitcnt lgkmcnt(2)
    v_mfma_f32_32x32x16_bf16 v[112:127], v[48:51], v[32:35], v[112:127]
    ds_read_b64_tr_b16 v[56:57], v25 offset:6144
    ds_read_b64_tr_b16 v[58:59], v25 offset:6656
    v_mfma_f32_32x32x16_bf16 v[128:143], v[32:35], v[52:55], v[128:143]
    ds_read_b64_tr_b16 v[60:61], v25 offset:14336
    ds_read_b64_tr_b16 v[62:63], v25 offset:14848
    v_mfma_f32_32x32x16_bf16 v[144:159], v[48:51], v[36:39], v[144:159]
    v_mfma_f32_32x32x16_bf16 v[160:175], v[36:39], v[52:55], v[160:175]
    s_waitcnt lgkmcnt(0)
    s_barrier
    v_mfma_f32_32x32x16_bf16 v[112:127], v[56:59], v[40:43], v[112:127]
    ds_read_b128 v[32:35], v20 offset:40960
    ds_read_b128 v[36:39], v20 offset:45056
    v_mfma_f32_32x32x16_bf16 v[128:143], v[40:43], v[60:63], v[128:143]
    ds_read_b64_tr_b16 v[48:49], v25 offset:40960
    ds_read_b64_tr_b16 v[50:51], v25 offset:41472
    v_mfma_f32_32x32x16_bf16 v[144:159], v[56:59], v[44:47], v[144:159]
    ds_read_b64_tr_b16 v[52:53], v25 offset:49152
    ds_read_b64_tr_b16 v[54:55], v25 offset:49664
    v_mfma_f32_32x32x16_bf16 v[160:175], v[44:47], v[60:63], v[160:175]
    ds_read_b128 v[40:43], v21 offset:40960
    ds_read_b128 v[44:47], v21 offset:45056
    s_waitcnt lgkmcnt(2)
    v_mfma_f32_32x32x16_bf16 v[112:127], v[48:51], v[32:35], v[112:127]
    ds_read_b64_tr_b16 v[56:57], v25 offset:43008
    ds_read_b64_tr_b16 v[58:59], v25 offset:43520
    v_mfma_f32_32x32x16_bf16 v[128:143], v[32:35], v[52:55], v[128:143]
    ds_read_b64_tr_b16 v[60:61], v25 offset:51200
    ds_read_b64_tr_b16 v[62:63], v25 offset:51712
    v_mfma_f32_32x32x16_bf16 v[144:159], v[48:51], v[36:39], v[144:159]
    v_mfma_f32_32x32x16_bf16 v[160:175], v[36:39], v[52:55], v[160:175]
    ds_read_b128 v[32:35], v22 offset:40960
    ds_read_b128 v[36:39], v22 offset:45056
    s_waitcnt lgkmcnt(2)
    v_mfma_f32_32x32x16_bf16 v[112:127], v[56:59], v[40:43], v[112:127]
    ds_read_b64_tr_b16 v[48:49], v25 offset:45056
    ds_read_b64_tr_b16 v[50:51], v25 offset:45568
    v_mfma_f32_32x32x16_bf16 v[128:143], v[40:43], v[60:63], v[128:143]
    ds_read_b64_tr_b16 v[52:53], v25 offset:53248
    ds_read_b64_tr_b16 v[54:55], v25 offset:53760
    v_mfma_f32_32x32x16_bf16 v[144:159], v[56:59], v[44:47], v[144:159]
    v_mfma_f32_32x32x16_bf16 v[160:175], v[44:47], v[60:63], v[160:175]
    ds_read_b128 v[40:43], v23 offset:40960
    ds_read_b128 v[44:47], v23 offset:45056
    s_waitcnt lgkmcnt(2)
    v_mfma_f32_32x32x16_bf16 v[112:127], v[48:51], v[32:35], v[112:127]
    ds_read_b64_tr_b16 v[56:57], v25 offset:47104
    ds_read_b64_tr_b16 v[58:59], v25 offset:47616
    v_mfma_f32_32x32x16_bf16 v[128:143], v[32:35], v[52:55], v[128:143]
    ds_read_b64_tr_b16 v[60:61], v25 offset:55296
    ds_read_b64_tr_b16 v[62:63], v25 offset:55808
    v_mfma_f32_32x32x16_bf16 v[144:159], v[48:51], v[36:39], v[144:159]
    v_mfma_f32_32x32x16_bf16 v[160:175], v[36:39], v[52:55], v[160:175]
    s_waitcnt lgkmcnt(0)
    s_barrier
    v_mfma_f32_32x32x16_bf16 v[112:127], v[56:59], v[40:43], v[112:127]
    v_mfma_f32_32x32x16_bf16 v[144:159], v[56:59], v[44:47], v[144:159]
    v_mfma_f32_32x32x16_bf16 v[128:143], v[40:43], v[60:63], v[128:143]
    v_mfma_f32_32x32x16_bf16 v[160:175], v[44:47], v[60:63], v[160:175]
    s_barrier
    s_branch L_p_end
L_g0:
    s_barrier
    s_call_b64 s[44:45], L_setup1
    s_call_b64 s[44:45], L_setup2
    v_and_b32 v6, 31, v0
    v_lshrrev_b32 v7, 5, v0
    v_bfe_u32 v8, v0, 1, 3
    v_xor_b32 v7, v7, v8
    v_lshlrev_b32 v7, 4, v7
    v_lshl_add_u32 v16, v6, 7, v7
    v_xor_b32 v17, 32, v16
    v_xor_b32 v18, 64, v16
    v_xor_b32 v19, 96, v16
    v_add_u32 v20, 81920, v16
    v_add_u32 v21, 81920, v17
    v_add_u32 v22, 81920, v18
    v_add_u32 v23, 81920, v19
    v_bfe_u32 v6, v0, 2, 2
    v_lshrrev_b32 v7, 5, v0
    v_lshl_add_u32 v7, v7, 3, v6
    v_lshrrev_b32 v6, 1, v6
    v_lshlrev_b32 v6, 6, v6
    v_lshl_add_u32 v6, v7, 7, v6
    v_bfe_u32 v7, v0, 4, 1
    v_lshl_add_u32 v6, v7, 5, v6
    v_and_b32 v7, 3, v0
    v_lshl_add_u32 v6, v7, 3, v6
    s_and_b32 s60, s52, 1
    s_lshl_b32 s61, s60, 6
    v_xor_b32 v24, s61, v6
    v_add_u32 v24, 8192, v24
    v_add_u32 v25, 81920, v24
    s_lshl_b32 s62, s54, 1
    s_add_u32 s62, s62, s60
    s_lshl_b32 s62, s62, 7
    s_lshl_b32 s61, s53, 1
    s_add_u32 s6, s62, s61
    s_lshl_b32 s60, s60, 11
    s_add_u32 s60, s60, 131072
    v_add_u32 v176, s60, v1
    s_lshl_b32 s6, s6, 10
    s_mov_b32 s16, s42
    s_mov_b32 s17, s43
    s_mov_b32 s18, 524288
    s_mov_b32 s19, 0x00020000
    s_mov_b32 s12, s48
    s_mov_b32 s13, s49
    s_mov_b32 s14, 524288
    s_mov_b32 s15, 0x00020000
    s_mov_b32 s8, s46
    s_mov_b32 s9, s47
    s_mov_b32 s10, 2097152
    s_mov_b32 s11, 0x00020000
    s_add_u32 s20, s50, 8388608
    s_addc_u32 s21, s51, 0
    s_mov_b32 s22, 131072
    s_mov_b32 s23, 0x00020000
    s_waitcnt lgkmcnt(0)
    s_add_u32 s55, s55, 1
    s_barrier
    ds_read_b128 v[32:35], v16 offset:0
    ds_read_b128 v[36:39], v16 offset:4096
    ds_read_b64_tr_b16 v[48:49], v24 offset:0
    ds_read_b64_tr_b16 v[50:51], v24 offset:512
    ds_read_b64_tr_b16 v[52:53], v24 offset:8192
    ds_read_b64_tr_b16 v[54:55], v24 offset:8704
    ds_read_b128 v[40:43], v17 offset:0
    ds_read_b128 v[44:47], v17 offset:4096
    s_waitcnt lgkmcnt(2)
    v_mfma_f32_32x32x16_bf16 v[112:127], v[48:51], v[32:35], 0
    ds_read_b64_tr_b16 v[56:57], v24 offset:2048
    ds_read_b64_tr_b16 v[58:59], v24 offset:2560
    v_mfma_f32_32x32x16_bf16 v[128:143], v[52:55], v[32:35], 0
    ds_read_b64_tr_b16 v[60:61], v24 offset:10240
    ds_read_b64_tr_b16 v[62:63], v24 offset:10752
    v_mfma_f32_32x32x16_bf16 v[144:159], v[48:51], v[36:39], 0
    v_mfma_f32_32x32x16_bf16 v[160:175], v[52:55], v[36:39], 0
    ds_read_b128 v[32:35], v18 offset:0
    ds_read_b128 v[36:39], v18 offset:4096
    s_waitcnt lgkmcnt(2)
    v_mfma_f32_32x32x16_bf16 v[112:127], v[56:59], v[40:43], v[112:127]
    ds_read_b64_tr_b16 v[48:49], v24 offset:4096
    ds_read_b64_tr_b16 v[50:51], v24 offset:4608
    v_mfma_f32_32x32x16_bf16 v[128:143], v[60:63], v[40:43], v[128:143]
    ds_read_b64_tr_b16 v[52:53], v24 offset:12288
    ds_read_b64_tr_b16 v[54:55], v24 offset:12800
    v_mfma_f32_32x32x16_bf16 v[144:159], v[56:59], v[44:47], v[144:159]
    v_mfma_f32_32x32x16_bf16 v[160:175], v[60:63], v[44:47], v[160:175]
    ds_read_b128 v[40:43], v19 offset:0
    ds_read_b128 v[44:47], v19 offset:4096
    s_waitcnt lgkmcnt(2)
    v_mfma_f32_32x32x16_bf16 v[112:127], v[48:51], v[32:35], v[112:127]
    ds_read_b64_tr_b16 v[56:57], v24 offset:6144
    ds_read_b64_tr_b16 v[58:59], v24 offset:6656
    v_mfma_f32_32x32x16_bf16 v[128:143], v[52:55], v[32:35], v[128:143]
    ds_read_b64_tr_b16 v[60:61], v24 offset:14336
    ds_read_b64_tr_b16 v[62:63], v24 offset:14848
    v_mfma_f32_32x32x16_bf16 v[144:159], v[48:51], v[36:39], v[144:159]
    v_mfma_f32_32x32x16_bf16 v[160:175], v[52:55], v[36:39], v[160:175]
    s_waitcnt lgkmcnt(0)
    s_barrier
    v_mfma_f32_32x32x16_bf16 v[112:127], v[56:59], v[40:43], v[112:127]
    ds_read_b128 v[32:35], v16 offset:40960
    ds_read_b128 v[36:39], v16 offset:45056
    v_mfma_f32_32x32x16_bf16 v[128:143], v[60:63], v[40:43], v[128:143]
    ds_read_b64_tr_b16 v[48:49], v24 offset:40960
    ds_read_b64_tr_b16 v[50:51], v24 offset:41472
    v_mfma_f32_32x32x16_bf16 v[144:159], v[56:59], v[44:47], v[144:159]
    ds_read_b64_tr_b16 v[52:53], v24 offset:49152
    ds_read_b64_tr_b16 v[54:55], v24 offset:49664
    v_mfma_f32_32x32x16_bf16 v[160:175], v[60:63], v[44:47], v[160:175]
    ds_read_b128 v[40:43], v17 offset:40960
    ds_read_b128 v[44:47], v17 offset:45056
    s_waitcnt lgkmcnt(2)
    v_mfma_f32_32x32x16_bf16 v[112:127], v[48:51], v[32:35], v[112:127]
    ds_read_b64_tr_b16 v[56:57], v24 offset:43008
    ds_read_b64_tr_b16 v[58:59], v24 offset:43520
    v_mfma_f32_32x32x16_bf16 v[128:143], v[52:55], v[32:35], v[128:143]
    ds_read_b64_tr_b16 v[60:61], v24 offset:51200
    ds_read_b64_tr_b16 v[62:63], v24 offset:51712
    v_mfma_f32_32x32x16_bf16 v[144:159], v[48:51], v[36:39], v[144:159]
    v_mfma_f32_32x32x16_bf16 v[160:175], v[52:55], v[36:39], v[160:175]
    ds_read_b128 v[32:35], v18 offset:40960
    ds_read_b128 v[36:39], v18 offset:45056
    s_waitcnt lgkmcnt(2)
    v_mfma_f32_32x32x16_bf16 v[112:127], v[56:59], v[40:43], v[112:127]
    ds_read_b64_tr_b16 v[48:49], v24 offset:45056
    ds_read_b64_tr_b16 v[50:51], v24 offset:45568
    v_mfma_f32_32x32x16_bf16 v[128:143], v[60:63], v[40:43], v[128:143]
    ds_read_b64_tr_b16 v[52:53], v24 offset:53248
    ds_read_b64_tr_b16 v[54:55], v24 offset:53760
    v_mfma_f32_32x32x16_bf16 v[144:159], v[56:59], v[44:47], v[144:159]
    v_mfma_f32_32x32x16_bf16 v[160:175], v[60:63], v[44:47], v[160:175]
    ds_read_b128 v[40:43], v19 offset:40960
    ds_read_b128 v[44:47], v19 offset:45056
    s_waitcnt lgkmcnt(2)
    v_mfma_f32_32x32x16_bf16 v[112:127], v[48:51], v[32:35], v[112:127]
    ds_read_b64_tr_b16 v[56:57], v24 offset:47104
    ds_read_b64_tr_b16 v[58:59], v24 offset:47616
    v_mfma_f32_32x32x16_bf16 v[128:143], v[52:55], v[32:35], v[128:143]
    ds_read_b64_tr_b16 v[60:61], v24 offset:55296
    ds_read_b64_tr_b16 v[62:63], v24 offset:55808
    v_mfma_f32_32x32x16_bf16 v[144:159], v[48:51], v[36:39], v[144:159]
    v_mfma_f32_32x32x16_bf16 v[160:175], v[52:55], v[36:39], v[160:175]
    s_waitcnt lgkmcnt(0)
    s_barrier
    v_mfma_f32_32x32x16_bf16 v[112:127], v[56:59], v[40:43], v[112:127]
    ds_read_b128 v[32:35], v20 offset:0
    ds_read_b128 v[36:39], v20 offset:4096
    v_mfma_f32_32x32x16_bf16 v[128:143], v[60:63], v[40:43], v[128:143]
    ds_read_b64_tr_b16 v[48:49], v25 offset:0
    ds_read_b64_tr_b16 v[50:51], v25 offset:512
    v_mfma_f32_32x32x16_bf16 v[144:159], v[56:59], v[44:47], v[144:159]
    ds_read_b64_tr_b16 v[52:53], v25 offset:8192
    ds_read_b64_tr_b16 v[54:55], v25 offset:8704
    v_mfma_f32_32x32x16_bf16 v[160:175], v[60:63], v[44:47], v[160:175]
    ds_read_b128 v[40:43], v21 offset:0
    ds_read_b128 v[44:47], v21 offset:4096
    s_waitcnt lgkmcnt(2)
    v_mfma_f32_32x32x16_bf16 v[112:127], v[48:51], v[32:35], v[112:127]
    ds_read_b64_tr_b16 v[56:57], v25 offset:2048
    ds_read_b64_tr_b16 v[58:59], v25 offset:2560
    v_mfma_f32_32x32x16_bf16 v[128:143], v[52:55], v[32:35], v[128:143]
    ds_read_b64_tr_b16 v[60:61], v25 offset:10240
    ds_read_b64_tr_b16 v[62:63], v25 offset:10752
    v_mfma_f32_32x32x16_bf16 v[144:159], v[48:51], v[36:39], v[144:159]
    v_mfma_f32_32x32x16_bf16 v[160:175], v[52:55], v[36:39], v[160:175]
    ds_read_b128 v[32:35], v22 offset:0
    ds_read_b128 v[36:39], v22 offset:4096
    s_waitcnt lgkmcnt(2)
    v_mfma_f32_32x32x16_bf16 v[112:127], v[56:59], v[40:43], v[112:127]
    ds_read_b64_tr_b16 v[48:49], v25 offset:4096
    ds_read_b64_tr_b16 v[50:51], v25 offset:4608
    v_mfma_f32_32x32x16_bf16 v[128:143], v[60:63], v[40:43], v[128:143]
    ds_read_b64_tr_b16 v[52:53], v25 offset:12288
    ds_read_b64_tr_b16 v[54:55], v25 offset:12800
    v_mfma_f32_32x32x16_bf16 v[144:159], v[56:59], v[44:47], v[144:159]
    v_mfma_f32_32x32x16_bf16 v[160:175], v[60:63], v[44:47], v[160:175]
    ds_read_b128 v[40:43], v23 offset:0
    ds_read_b128 v[44:47], v23 offset:4096
    s_waitcnt lgkmcnt(2)
    v_mfma_f32_32x32x16_bf16 v[112:127], v[48:51], v[32:35], v[112:127]
    ds_read_b64_tr_b16 v[56:57], v25 offset:6144
    ds_read_b64_tr_b16 v[58:59], v25 offset:6656
    v_mfma_f32_32x32x16_bf16 v[128:143], v[52:55], v[32:35], v[128:143]
    ds_read_b64_tr_b16 v[60:61], v25 offset:14336
    ds_read_b64_tr_b16 v[62:63], v25 offset:14848
    v_mfma_f32_32x32x16_bf16 v[144:159], v[48:51], v[36:39], v[144:159]
    v_mfma_f32_32x32x16_bf16 v[160:175], v[52:55], v[36:39], v[160:175]
    s_waitcnt lgkmcnt(0)
    s_barrier
    v_mfma_f32_32x32x16_bf16 v[112:127], v[56:59], v[40:43], v[112:127]
    ds_read_b128 v[32:35], v20 offset:40960
    ds_read_b128 v[36:39], v20 offset:45056
    v_mfma_f32_32x32x16_bf16 v[128:143], v[60:63], v[40:43], v[128:143]
    ds_read_b64_tr_b16 v[48:49], v25 offset:40960
    ds_read_b64_tr_b16 v[50:51], v25 offset:41472
    v_mfma_f32_32x32x16_bf16 v[144:159], v[56:59], v[44:47], v[144:159]
    ds_read_b64_tr_b16 v[52:53], v25 offset:49152
    ds_read_b64_tr_b16 v[54:55], v25 offset:49664
    v_mfma_f32_32x32x16_bf16 v[160:175], v[60:63], v[44:47], v[160:175]
    ds_read_b128 v[40:43], v21 offset:40960
    ds_read_b128 v[44:47], v21 offset:45056
    s_waitcnt lgkmcnt(2)
    v_mfma_f32_32x32x16_bf16 v[112:127], v[48:51], v[32:35], v[112:127]
    ds_read_b64_tr_b16 v[56:57], v25 offset:43008
    ds_read_b64_tr_b16 v[58:59], v25 offset:43520
    v_mfma_f32_32x32x16_bf16 v[128:143], v[52:55], v[32:35], v[128:143]
    ds_read_b64_tr_b16 v[60:61], v25 offset:51200
    ds_read_b64_tr_b16 v[62:63], v25 offset:51712
    v_mfma_f32_32x32x16_bf16 v[144:159], v[48:51], v[36:39], v[144:159]
    v_mfma_f32_32x32x16_bf16 v[160:175], v[52:55], v[36:39], v[160:175]
    ds_read_b128 v[32:35], v22 offset:40960
    ds_read_b128 v[36:39], v22 offset:45056
    s_waitcnt lgkmcnt(2)
    v_mfma_f32_32x32x16_bf16 v[112:127], v[56:59], v[40:43], v[112:127]
    ds_read_b64_tr_b16 v[48:49], v25 offset:45056
    ds_read_b64_tr_b16 v[50:51], v25 offset:45568
    v_mfma_f32_32x32x16_bf16 v[128:143], v[60:63], v[40:43], v[128:143]
    ds_read_b64_tr_b16 v[52:53], v25 offset:53248
    ds_read_b64_tr_b16 v[54:55], v25 offset:53760
    v_mfma_f32_32x32x16_bf16 v[144:159], v[56:59], v[44:47], v[144:159]
    v_mfma_f32_32x32x16_bf16 v[160:175], v[60:63], v[44:47], v[160:175]
    ds_read_b128 v[40:43], v23 offset:40960
    ds_read_b128 v[44:47], v23 offset:45056
    s_waitcnt lgkmcnt(2)
    v_mfma_f32_32x32x16_bf16 v[112:127], v[48:51], v[32:35], v[112:127]
    ds_read_b64_tr_b16 v[56:57], v25 offset:47104
    ds_read_b64_tr_b16 v[58:59], v25 offset:47616
    v_mfma_f32_32x32x16_bf16 v[128:143], v[52:55], v[32:35], v[128:143]
    ds_read_b64_tr_b16 v[60:61], v25 offset:55296
    ds_read_b64_tr_b16 v[62:63], v25 offset:55808
    v_mfma_f32_32x32x16_bf16 v[144:159], v[48:51], v[36:39], v[144:159]
    v_mfma_f32_32x32x16_bf16 v[160:175], v[52:55], v[36:39], v[160:175]
    s_waitcnt lgkmcnt(0)
    s_barrier
    v_mfma_f32_32x32x16_bf16 v[112:127], v[56:59], v[40:43], v[112:127]
    ds_read_b128 v[32:35], v16 offset:0
    ds_read_b128 v[36:39], v16 offset:4096
    v_mfma_f32_32x32x16_bf16 v[128:143], v[60:63], v[40:43], v[128:143]
    ds_read_b64_tr_b16 v[48:49], v24 offset:0
    ds_read_b64_tr_b16 v[50:51], v24 offset:512
    v_mfma_f32_32x32x16_bf16 v[144:159], v[56:59], v[44:47], v[144:159]
    ds_read_b64_tr_b16 v[52:53], v24 offset:8192
    ds_read_b64_tr_b16 v[54:55], v24 offset:8704
    v_mfma_f32_32x32x16_bf16 v[160:175], v[60:63], v[44:47], v[160:175]
    ds_read_b128 v[40:43], v17 offset:0
    ds_read_b128 v[44:47], v17 offset:4096
    s_waitcnt lgkmcnt(2)
    v_mfma_f32_32x32x16_bf16 v[112:127], v[48:51], v[32:35], v[112:127]
    ds_read_b64_tr_b16 v[56:57], v24 offset:2048
    ds_read_b64_tr_b16 v[58:59], v24 offset:2560
    v_mfma_f32_32x32x16_bf16 v[128:143], v[52:55], v[32:35], v[128:143]
    ds_read_b64_tr_b16 v[60:61], v24 offset:10240
    ds_read_b64_tr_b16 v[62:63], v24 offset:10752
    v_mfma_f32_32x32x16_bf16 v[144:159], v[48:51], v[36:39], v[144:159]
    v_mfma_f32_32x32x16_bf16 v[160:175], v[52:55], v[36:39], v[160:175]
    ds_read_b128 v[32:35], v18 offset:0
    ds_read_b128 v[36:39], v18 offset:4096
    s_waitcnt lgkmcnt(2)
    v_mfma_f32_32x32x16_bf16 v[112:127], v[56:59], v[40:43], v[112:127]
    ds_read_b64_tr_b16 v[48:49], v24 offset:4096
    ds_read_b64_tr_b16 v[50:51], v24 offset:4608
    v_mfma_f32_32x32x16_bf16 v[128:143], v[60:63], v[40:43], v[128:143]
    ds_read_b64_tr_b16 v[52:53], v24 offset:12288
    ds_read_b64_tr_b16 v[54:55], v24 offset:12800
    v_mfma_f32_32x32x16_bf16 v[144:159], v[56:59], v[44:47], v[144:159]
    v_mfma_f32_32x32x16_bf16 v[160:175], v[60:63], v[44:47], v[160:175]
    ds_read_b128 v[40:43], v19 offset:0
    ds_read_b128 v[44:47], v19 offset:4096
    s_waitcnt lgkmcnt(2)
    v_mfma_f32_32x32x16_bf16 v[112:127], v[48:51], v[32:35], v[112:127]
    ds_read_b64_tr_b16 v[56:57], v24 offset:6144
    ds_read_b64_tr_b16 v[58:59], v24 offset:6656
    v_mfma_f32_32x32x16_bf16 v[128:143], v[52:55], v[32:35], v[128:143]
    ds_read_b64_tr_b16 v[60:61], v24 offset:14336
    ds_read_b64_tr_b16 v[62:63], v24 offset:14848
    v_mfma_f32_32x32x16_bf16 v[144:159], v[48:51], v[36:39], v[144:159]
    v_mfma_f32_32x32x16_bf16 v[160:175], v[52:55], v[36:39], v[160:175]
    s_waitcnt lgkmcnt(0)
    s_barrier
    v_mfma_f32_32x32x16_bf16 v[112:127], v[56:59], v[40:43], v[112:127]
    ds_read_b128 v[32:35], v16 offset:40960
    ds_read_b128 v[36:39], v16 offset:45056
    v_mfma_f32_32x32x16_bf16 v[128:143], v[60:63], v[40:43], v[128:143]
    ds_read_b64_tr_b16 v[48:49], v24 offset:40960
    ds_read_b64_tr_b16 v[50:51], v24 offset:41472
    v_mfma_f32_32x32x16_bf16 v[144:159], v[56:59], v[44:47], v[144:159]
    ds_read_b64_tr_b16 v[52:53], v24 offset:49152
    ds_read_b64_tr_b16 v[54:55], v24 offset:49664
    v_mfma_f32_32x32x16_bf16 v[160:175], v[60:63], v[44:47], v[160:175]
    ds_read_b128 v[40:43], v17 offset:40960
    ds_read_b128 v[44:47], v17 offset:45056
    s_waitcnt lgkmcnt(2)
    v_mfma_f32_32x32x16_bf16 v[112:127], v[48:51], v[32:35], v[112:127]
    ds_read_b64_tr_b16 v[56:57], v24 offset:43008
    ds_read_b64_tr_b16 v[58:59], v24 offset:43520
    v_mfma_f32_32x32x16_bf16 v[128:143], v[52:55], v[32:35], v[128:143]
    ds_read_b64_tr_b16 v[60:61], v24 offset:51200
    ds_read_b64_tr_b16 v[62:63], v24 offset:51712
    v_mfma_f32_32x32x16_bf16 v[144:159], v[48:51], v[36:39], v[144:159]
    v_mfma_f32_32x32x16_bf16 v[160:175], v[52:55], v[36:39], v[160:175]
    ds_read_b128 v[32:35], v18 offset:40960
    ds_read_b128 v[36:39], v18 offset:45056
    s_waitcnt lgkmcnt(2)
    v_mfma_f32_32x32x16_bf16 v[112:127], v[56:59], v[40:43], v[112:127]
    ds_read_b64_tr_b16 v[48:49], v24 offset:45056
    ds_read_b64_tr_b16 v[50:51], v24 offset:45568
    v_mfma_f32_32x32x16_bf16 v[128:143], v[60:63], v[40:43], v[128:143]
    ds_read_b64_tr_b16 v[52:53], v24 offset:53248
    ds_read_b64_tr_b16 v[54:55], v24 offset:53760
    v_mfma_f32_32x32x16_bf16 v[144:159], v[56:59], v[44:47], v[144:159]
    v_mfma_f32_32x32x16_bf16 v[160:175], v[60:63], v[44:47], v[160:175]
    ds_read_b128 v[40:43], v19 offset:40960
    ds_read_b128 v[44:47], v19 offset:45056
    s_waitcnt lgkmcnt(2)
    v_mfma_f32_32x32x16_bf16 v[112:127], v[48:51], v[32:35], v[112:127]
    ds_read_b64_tr_b16 v[56:57], v24 offset:47104
    ds_read_b64_tr_b16 v[58:59], v24 offset:47616
    v_mfma_f32_32x32x16_bf16 v[128:143], v[52:55], v[32:35], v[128:143]
    ds_read_b64_tr_b16 v[60:61], v24 offset:55296
    ds_read_b64_tr_b16 v[62:63], v24 offset:55808
    v_mfma_f32_32x32x16_bf16 v[144:159], v[48:51], v[36:39], v[144:159]
    v_mfma_f32_32x32x16_bf16 v[160:175], v[52:55], v[36:39], v[160:175]
    s_waitcnt lgkmcnt(0)
    s_barrier
    v_mfma_f32_32x32x16_bf16 v[112:127], v[56:59], v[40:43], v[112:127]
    ds_read_b128 v[32:35], v20 offset:0
    ds_read_b128 v[36:39], v20 offset:4096
    v_mfma_f32_32x32x16_bf16 v[128:143], v[60:63], v[40:43], v[128:143]
    ds_read_b64_tr_b16 v[48:49], v25 offset:0
    ds_read_b64_tr_b16 v[50:51], v25 offset:512
    v_mfma_f32_32x32x16_bf16 v[144:159], v[56:59], v[44:47], v[144:159]
    ds_read_b64_tr_b16 v[52:53], v25 offset:8192
    ds_read_b64_tr_b16 v[54:55], v25 offset:8704
    v_mfma_f32_32x32x16_bf16 v[160:175], v[60:63], v[44:47], v[160:175]
    ds_read_b128 v[40:43], v21 offset:0
    ds_read_b128 v[44:47], v21 offset:4096
    s_waitcnt lgkmcnt(2)
    v_mfma_f32_32x32x16_bf16 v[112:127], v[48:51], v[32:35], v[112:127]
    ds_read_b64_tr_b16 v[56:57], v25 offset:2048
    ds_read_b64_tr_b16 v[58:59], v25 offset:2560
    v_mfma_f32_32x32x16_bf16 v[128:143], v[52:55], v[32:35], v[128:143]
    ds_read_b64_tr_b16 v[60:61], v25 offset:10240
    ds_read_b64_tr_b16 v[62:63], v25 offset:10752
    v_mfma_f32_32x32x16_bf16 v[144:159], v[48:51], v[36:39], v[144:159]
    v_mfma_f32_32x32x16_bf16 v[160:175], v[52:55], v[36:39], v[160:175]
    ds_read_b128 v[32:35], v22 offset:0
    ds_read_b128 v[36:39], v22 offset:4096
    s_waitcnt lgkmcnt(2)
    v_mfma_f32_32x32x16_bf16 v[112:127], v[56:59], v[40:43], v[112:127]
    ds_read_b64_tr_b16 v[48:49], v25 offset:4096
    ds_read_b64_tr_b16 v[50:51], v25 offset:4608
    v_mfma_f32_32x32x16_bf16 v[128:143], v[60:63], v[40:43], v[128:143]
    ds_read_b64_tr_b16 v[52:53], v25 offset:12288
    ds_read_b64_tr_b16 v[54:55], v25 offset:12800
    v_mfma_f32_32x32x16_bf16 v[144:159], v[56:59], v[44:47], v[144:159]
    v_mfma_f32_32x32x16_bf16 v[160:175], v[60:63], v[44:47], v[160:175]
    ds_read_b128 v[40:43], v23 offset:0
    ds_read_b128 v[44:47], v23 offset:4096
    s_waitcnt lgkmcnt(2)
    v_mfma_f32_32x32x16_bf16 v[112:127], v[48:51], v[32:35], v[112:127]
    ds_read_b64_tr_b16 v[56:57], v25 offset:6144
    ds_read_b64_tr_b16 v[58:59], v25 offset:6656
    v_mfma_f32_32x32x16_bf16 v[128:143], v[52:55], v[32:35], v[128:143]
    ds_read_b64_tr_b16 v[60:61], v25 offset:14336
    ds_read_b64_tr_b16 v[62:63], v25 offset:14848
    v_mfma_f32_32x32x16_bf16 v[144:159], v[48:51], v[36:39], v[144:159]
    v_mfma_f32_32x32x16_bf16 v[160:175], v[52:55], v[36:39], v[160:175]
    s_waitcnt lgkmcnt(0)
    s_barrier
    v_mfma_f32_32x32x16_bf16 v[112:127], v[56:59], v[40:43], v[112:127]
    ds_read_b128 v[32:35], v20 offset:40960
    ds_read_b128 v[36:39], v20 offset:45056
    v_mfma_f32_32x32x16_bf16 v[128:143], v[60:63], v[40:43], v[128:143]
    ds_read_b64_tr_b16 v[48:49], v25 offset:40960
    ds_read_b64_tr_b16 v[50:51], v25 offset:41472
    v_mfma_f32_32x32x16_bf16 v[144:159], v[56:59], v[44:47], v[144:159]
    ds_read_b64_tr_b16 v[52:53], v25 offset:49152
    ds_read_b64_tr_b16 v[54:55], v25 offset:49664
    v_mfma_f32_32x32x16_bf16 v[160:175], v[60:63], v[44:47], v[160:175]
    ds_read_b128 v[40:43], v21 offset:40960
    ds_read_b128 v[44:47], v21 offset:45056
    s_waitcnt lgkmcnt(2)
    v_mfma_f32_32x32x16_bf16 v[112:127], v[48:51], v[32:35], v[112:127]
    ds_read_b64_tr_b16 v[56:57], v25 offset:43008
    ds_read_b64_tr_b16 v[58:59], v25 offset:43520
    v_mfma_f32_32x32x16_bf16 v[128:143], v[52:55], v[32:35], v[128:143]
    ds_read_b64_tr_b16 v[60:61], v25 offset:51200
    ds_read_b64_tr_b16 v[62:63], v25 offset:51712
    v_mfma_f32_32x32x16_bf16 v[144:159], v[48:51], v[36:39], v[144:159]
    v_mfma_f32_32x32x16_bf16 v[160:175], v[52:55], v[36:39], v[160:175]
    ds_read_b128 v[32:35], v22 offset:40960
    ds_read_b128 v[36:39], v22 offset:45056
    s_waitcnt lgkmcnt(2)
    v_mfma_f32_32x32x16_bf16 v[112:127], v[56:59], v[40:43], v[112:127]
    ds_read_b64_tr_b16 v[48:49], v25 offset:45056
    ds_read_b64_tr_b16 v[50:51], v25 offset:45568
    v_mfma_f32_32x32x16_bf16 v[128:143], v[60:63], v[40:43], v[128:143]
    ds_read_b64_tr_b16 v[52:53], v25 offset:53248
    ds_read_b64_tr_b16 v[54:55], v25 offset:53760
    v_mfma_f32_32x32x16_bf16 v[144:159], v[56:59], v[44:47], v[144:159]
    v_mfma_f32_32x32x16_bf16 v[160:175], v[60:63], v[44:47], v[160:175]
    ds_read_b128 v[40:43], v23 offset:40960
    ds_read_b128 v[44:47], v23 offset:45056
    s_waitcnt lgkmcnt(2)
    v_mfma_f32_32x32x16_bf16 v[112:127], v[48:51], v[32:35], v[112:127]
    ds_read_b64_tr_b16 v[56:57], v25 offset:47104
    ds_read_b64_tr_b16 v[58:59], v25 offset:47616
    v_mfma_f32_32x32x16_bf16 v[128:143], v[52:55], v[32:35], v[128:143]
    ds_read_b64_tr_b16 v[60:61], v25 offset:55296
    ds_read_b64_tr_b16 v[62:63], v25 offset:55808
    v_mfma_f32_32x32x16_bf16 v[144:159], v[48:51], v[36:39], v[144:159]
    v_mfma_f32_32x32x16_bf16 v[160:175], v[52:55], v[36:39], v[160:175]
    s_waitcnt lgkmcnt(0)
    s_barrier
    v_mfma_f32_32x32x16_bf16 v[112:127], v[56:59], v[40:43], v[112:127]
    v_mfma_f32_32x32x16_bf16 v[144:159], v[56:59], v[44:47], v[144:159]
    v_mfma_f32_32x32x16_bf16 v[128:143], v[60:63], v[40:43], v[128:143]
    v_mfma_f32_32x32x16_bf16 v[160:175], v[60:63], v[44:47], v[160:175]
    s_nop 8
    v_pk_mul_f32 v[112:113], v[112:113], s[66:67] op_sel:[0,1] op_sel_hi:[1,1]
    v_pk_mul_f32 v[114:115], v[114:115], s[66:67] op_sel:[0,1] op_sel_hi:[1,1]
    v_pk_mul_f32 v[116:117], v[116:117], s[66:67] op_sel:[0,1] op_sel_hi:[1,1]
    v_pk_mul_f32 v[118:119], v[118:119], s[66:67] op_sel:[0,1] op_sel_hi:[1,1]
    v_pk_mul_f32 v[120:121], v[120:121], s[66:67] op_sel:[0,1] op_sel_hi:[1,1]
    v_pk_mul_f32 v[122:123], v[122:123], s[66:67] op_sel:[0,1] op_sel_hi:[1,1]
    v_pk_mul_f32 v[124:125], v[124:125], s[66:67] op_sel:[0,1] op_sel_hi:[1,1]
    v_pk_mul_f32 v[126:127], v[126:127], s[66:67] op_sel:[0,1] op_sel_hi:[1,1]
    v_cvt_pk_bf16_f32 v112, v112, v113
    v_cvt_pk_bf16_f32 v113, v114, v115
    v_cvt_pk_bf16_f32 v114, v116, v117
    v_cvt_pk_bf16_f32 v115, v118, v119
    v_cvt_pk_bf16_f32 v116, v120, v121
    v_cvt_pk_bf16_f32 v117, v122, v123
    v_cvt_pk_bf16_f32 v118, v124, v125
    v_cvt_pk_bf16_f32 v119, v126, v127
    ds_write_b128 v176, v[112:115] offset:0
    ds_write_b128 v176, v[116:119] offset:1024
    v_pk_mul_f32 v[144:145], v[144:145], s[66:67] op_sel:[0,1] op_sel_hi:[1,1]
    v_pk_mul_f32 v[146:147], v[146:147], s[66:67] op_sel:[0,1] op_sel_hi:[1,1]
    v_pk_mul_f32 v[148:149], v[148:149], s[66:67] op_sel:[0,1] op_sel_hi:[1,1]
    v_pk_mul_f32 v[150:151], v[150:151], s[66:67] op_sel:[0,1] op_sel_hi:[1,1]
    v_pk_mul_f32 v[152:153], v[152:153], s[66:67] op_sel:[0,1] op_sel_hi:[1,1]
    v_pk_mul_f32 v[154:155], v[154:155], s[66:67] op_sel:[0,1] op_sel_hi:[1,1]
    v_pk_mul_f32 v[156:157], v[156:157], s[66:67] op_sel:[0,1] op_sel_hi:[1,1]
    v_pk_mul_f32 v[158:159], v[158:159], s[66:67] op_sel:[0,1] op_sel_hi:[1,1]
    v_cvt_pk_bf16_f32 v144, v144, v145
    v_cvt_pk_bf16_f32 v145, v146, v147
    v_cvt_pk_bf16_f32 v146, v148, v149
    v_cvt_pk_bf16_f32 v147, v150, v151
    v_cvt_pk_bf16_f32 v148, v152, v153
    v_cvt_pk_bf16_f32 v149, v154, v155
    v_cvt_pk_bf16_f32 v150, v156, v157
    v_cvt_pk_bf16_f32 v151, v158, v159
    ds_write_b128 v176, v[144:147] offset:4096
    ds_write_b128 v176, v[148:151] offset:5120
    s_waitcnt lgkmcnt(0)
    s_barrier
L_p_end:
    ds_read_b128 a[0:3], v11
    ds_read_b128 a[4:7], v11 offset:1024
    ds_read_b128 a[40:43], v2
    s_setprio 0
    s_cmp_eq_u32 s76, 0
    s_cbranch_scc1 L_prio0
    s_setprio 1
L_prio0:
    s_waitcnt lgkmcnt(0)
    ds_read_b128 a[16:19], v2
    s_mov_b64 exec, s[68:69]
    ds_read_b128 a[20:23], v3 offset:1024
    ds_read_b128 a[24:27], v3 offset:1536
    s_mov_b64 exec, -1
L_max:
    v_mfma_f32_32x32x16_bf16 v[16:31], a[40:43], a[0:3], 0
    v_mfma_f32_32x32x16_bf16 v[32:47], a[40:43], a[4:7], 0
    v_pk_mov_b32 v[80:81], 0, 0
    v_pk_mov_b32 v[82:83], 0, 0
    v_pk_mov_b32 v[84:85], 0, 0
    v_pk_mov_b32 v[86:87], 0, 0
    v_pk_mov_b32 v[88:89], 0, 0
    v_pk_mov_b32 v[90:91], 0, 0
    v_pk_mov_b32 v[92:93], 0, 0
    v_pk_mov_b32 v[94:95], 0, 0
    v_pk_mov_b32 v[96:97], 0, 0
    v_pk_mov_b32 v[98:99], 0, 0
    v_pk_mov_b32 v[100:101], 0, 0
    v_pk_mov_b32 v[102:103], 0, 0
    v_pk_mov_b32 v[104:105], 0, 0
    v_pk_mov_b32 v[106:107], 0, 0
    v_pk_mov_b32 v[108:109], 0, 0
    v_pk_mov_b32 v[110:111], 0, 0
    v_max3_f32 v12, v16, v17, v18
    v_max3_f32 v6, v19, v20, v21
    v_max3_f32 v8, v22, v23, v24
    v_max3_f32 v9, v25, v26, v27
    v_max3_f32 v12, v12, v28, v29
    v_max3_f32 v6, v6, v30, v31
    v_max3_f32 v12, v12, v8, v9
    v_max_f32 v12, v12, v6
    v_max3_f32 v13, v32, v33, v34
    v_max3_f32 v6, v35, v36, v37
    v_max3_f32 v8, v38, v39, v40
    v_max3_f32 v9, v41, v42, v43
    v_max3_f32 v13, v13, v44, v45
    v_max3_f32 v6, v6, v46, v47
    v_max3_f32 v13, v13, v8, v9
    v_max_f32 v13, v13, v6
    v_mov_b32 v6, v12
    v_mov_b32 v8, v13
    s_nop 0
    v_permlane32_swap_b32 v6, v12
    v_permlane32_swap_b32 v8, v13
    s_nop 0
    v_max_f32 v6, v6, v12
    v_max_f32 v8, v8, v13
    v_ceil_f32 v6, v6
    v_ceil_f32 v8, v8
    v_sub_f32 v16, 0xc2be0000, v6
    v_sub_f32 v17, 0xc2be0000, v6
    v_sub_f32 v32, 0xc2be0000, v8
    v_sub_f32 v33, 0xc2be0000, v8
    v_pk_mov_b32 v[18:19], v[16:17], v[16:17]
    v_pk_mov_b32 v[20:21], v[16:17], v[16:17]
    v_pk_mov_b32 v[22:23], v[16:17], v[16:17]
    v_pk_mov_b32 v[24:25], v[16:17], v[16:17]
    v_pk_mov_b32 v[26:27], v[16:17], v[16:17]
    v_pk_mov_b32 v[28:29], v[16:17], v[16:17]
    v_pk_mov_b32 v[30:31], v[16:17], v[16:17]
    v_pk_mov_b32 v[34:35], v[32:33], v[32:33]
    v_pk_mov_b32 v[36:37], v[32:33], v[32:33]
    v_pk_mov_b32 v[38:39], v[32:33], v[32:33]
    v_pk_mov_b32 v[40:41], v[32:33], v[32:33]
    v_pk_mov_b32 v[42:43], v[32:33], v[32:33]
    v_pk_mov_b32 v[44:45], v[32:33], v[32:33]
    v_pk_mov_b32 v[46:47], v[32:33], v[32:33]
    s_cmp_eq_u32 s7, 0
    s_cbranch_scc1 L_nopend
    s_barrier
    ds_read_b128 a[16:19], v2
    s_mov_b64 exec, s[68:69]
    ds_read_b128 a[20:23], v3 offset:1024
    ds_read_b128 a[24:27], v3 offset:1536
    s_mov_b64 exec, -1
L_nopend:
    s_mov_b32 s57, s34
    s_lshl_b32 s56, s59, 1
    s_add_u32 s56, s56, s76
    s_waitcnt lgkmcnt(0)
    v_mfma_f32_32x32x16_bf16 v[48:63], a[16:19], a[0:3], v[16:31]
    s_nop 11
.p2align 6
L_loop:
    s_cmp_eq_u32 s56, 0
    s_cbranch_scc0 L_pr_1
    s_setprio 2
L_pr_1:
    s_cmp_eq_u32 s56, 2
    s_cbranch_scc0 L_pr_2
    s_setprio 2
L_pr_2:
    v_exp_f32 v48, v48
    v_exp_f32 v49, v49
    ds_read_b128 a[28:31], v2 offset:2048
    s_mov_b64 exec, s[68:69]
    ds_read_b128 a[32:35], v3 offset:3072
    ds_read_b128 a[36:39], v3 offset:3584
    s_mov_b64 exec, -1
    v_exp_f32 v50, v50
    v_exp_f32 v51, v51
    v_exp_f32 v52, v52
    v_mfma_f32_32x32x16_bf16 v[64:79], a[16:19], a[4:7], v[32:47]
    v_exp_f32 v53, v53
    v_exp_f32 v54, v54
    v_exp_f32 v55, v55
    v_exp_f32 v56, v56
    v_exp_f32 v57, v57
    v_smfmac_f32_32x32x32_bf16 v[80:95], a[20:23], v[48:55], v4
    s_mov_b32 m0, s57
    v_exp_f32 v58, v58
    buffer_load_dwordx4 v1, s[20:23], s57 offen offset:0 sc1 lds
    v_exp_f32 v59, v59
    buffer_load_dwordx4 v1, s[20:23], s57 offen offset:1024 sc1 lds
    v_exp_f32 v60, v60
    buffer_load_dwordx4 v1, s[20:23], s57 offen offset:2048 sc1 lds
    v_exp_f32 v61, v61
    buffer_load_dwordx4 v1, s[20:23], s57 offen offset:3072 sc1 lds
    v_exp_f32 v62, v62
    v_exp_f32 v63, v63
    v_exp_f32 v64, v64
    v_exp_f32 v65, v65
    v_smfmac_f32_32x32x32_bf16 v[80:95], a[24:27], v[56:63], v4
    v_exp_f32 v66, v66
    v_exp_f32 v67, v67
    v_exp_f32 v68, v68
    s_waitcnt lgkmcnt(0)
    v_mfma_f32_32x32x16_bf16 v[48:63], a[28:31], a[0:3], v[16:31]
    v_exp_f32 v69, v69
    v_exp_f32 v70, v70
    v_exp_f32 v71, v71
    v_exp_f32 v72, v72
    v_exp_f32 v73, v73
    v_smfmac_f32_32x32x32_bf16 v[96:111], a[20:23], v[64:71], v4
    s_add_u32 s57, s57, 4096
    s_mov_b32 m0, s57
    v_exp_f32 v74, v74
    buffer_load_dwordx4 v1, s[20:23], s57 offen offset:0 sc1 lds
    v_exp_f32 v75, v75
    buffer_load_dwordx4 v1, s[20:23], s57 offen offset:1024 sc1 lds
    v_exp_f32 v76, v76
    buffer_load_dwordx4 v1, s[20:23], s57 offen offset:2048 sc1 lds
    v_exp_f32 v77, v77
    buffer_load_dwordx4 v1, s[20:23], s57 offen offset:3072 sc1 lds
    v_exp_f32 v78, v78
    v_exp_f32 v79, v79
    v_exp_f32 v48, v48
    v_exp_f32 v49, v49
    v_smfmac_f32_32x32x32_bf16 v[96:111], a[24:27], v[72:79], v4
    ds_read_b128 a[16:19], v2 offset:4096
    s_mov_b64 exec, s[68:69]
    ds_read_b128 a[20:23], v3 offset:5120
    ds_read_b128 a[24:27], v3 offset:5632
    s_mov_b64 exec, -1
    v_exp_f32 v50, v50
    v_exp_f32 v51, v51
    v_exp_f32 v52, v52
    v_mfma_f32_32x32x16_bf16 v[64:79], a[28:31], a[4:7], v[32:47]
    v_exp_f32 v53, v53
    v_exp_f32 v54, v54
    v_exp_f32 v55, v55
    v_exp_f32 v56, v56
    v_exp_f32 v57, v57
    v_smfmac_f32_32x32x32_bf16 v[80:95], a[32:35], v[48:55], v4
    s_add_u32 s57, s57, 4096
    s_mov_b32 m0, s57
    v_exp_f32 v58, v58
    buffer_load_dwordx4 v1, s[20:23], s57 offen offset:0 sc1 lds
    v_exp_f32 v59, v59
    buffer_load_dwordx4 v1, s[20:23], s57 offen offset:1024 sc1 lds
    v_exp_f32 v60, v60
    buffer_load_dwordx4 v1, s[20:23], s57 offen offset:2048 sc1 lds
    v_exp_f32 v61, v61
    buffer_load_dwordx4 v1, s[20:23], s57 offen offset:3072 sc1 lds
    v_exp_f32 v62, v62
    v_exp_f32 v63, v63
    v_exp_f32 v64, v64
    v_exp_f32 v65, v65
    v_smfmac_f32_32x32x32_bf16 v[80:95], a[36:39], v[56:63], v4
    v_exp_f32 v66, v66
    v_exp_f32 v67, v67
    v_exp_f32 v68, v68
    s_waitcnt lgkmcnt(0)
    v_mfma_f32_32x32x16_bf16 v[48:63], a[16:19], a[0:3], v[16:31]
    v_exp_f32 v69, v69
    v_exp_f32 v70, v70
    v_exp_f32 v71, v71
    v_exp_f32 v72, v72
    v_exp_f32 v73, v73
    v_smfmac_f32_32x32x32_bf16 v[96:111], a[32:35], v[64:71], v4
    v_exp_f32 v74, v74
    v_exp_f32 v75, v75
    v_exp_f32 v76, v76
    v_exp_f32 v77, v77
    v_exp_f32 v78, v78
    v_exp_f32 v79, v79
    v_exp_f32 v48, v48
    v_exp_f32 v49, v49
    v_smfmac_f32_32x32x32_bf16 v[96:111], a[36:39], v[72:79], v4
    ds_read_b128 a[28:31], v2 offset:6144
    s_mov_b64 exec, s[68:69]
    ds_read_b128 a[32:35], v3 offset:7168
    ds_read_b128 a[36:39], v3 offset:7680
    s_mov_b64 exec, -1
    v_exp_f32 v50, v50
    v_exp_f32 v51, v51
    v_exp_f32 v52, v52
    v_mfma_f32_32x32x16_bf16 v[64:79], a[16:19], a[4:7], v[32:47]
    v_exp_f32 v53, v53
    v_exp_f32 v54, v54
    v_exp_f32 v55, v55
    v_exp_f32 v56, v56
    v_exp_f32 v57, v57
    v_smfmac_f32_32x32x32_bf16 v[80:95], a[20:23], v[48:55], v4
    v_exp_f32 v58, v58
    v_exp_f32 v59, v59
    v_exp_f32 v60, v60
    v_exp_f32 v61, v61
    v_exp_f32 v62, v62
    v_exp_f32 v63, v63
    v_exp_f32 v64, v64
    v_exp_f32 v65, v65
    v_smfmac_f32_32x32x32_bf16 v[80:95], a[24:27], v[56:63], v4
    v_exp_f32 v66, v66
    v_exp_f32 v67, v67
    v_exp_f32 v68, v68
    s_waitcnt lgkmcnt(0)
    v_mfma_f32_32x32x16_bf16 v[48:63], a[28:31], a[0:3], v[16:31]
    v_exp_f32 v69, v69
    v_exp_f32 v70, v70
    v_exp_f32 v71, v71
    v_exp_f32 v72, v72
    v_exp_f32 v73, v73
    v_smfmac_f32_32x32x32_bf16 v[96:111], a[20:23], v[64:71], v4
    v_exp_f32 v74, v74
    v_exp_f32 v75, v75
    v_exp_f32 v76, v76
    v_exp_f32 v77, v77
    v_exp_f32 v78, v78
    v_exp_f32 v79, v79
    v_exp_f32 v48, v48
    v_exp_f32 v49, v49
    v_smfmac_f32_32x32x32_bf16 v[96:111], a[24:27], v[72:79], v4
    ds_read_b128 a[16:19], v2 offset:8192
    s_mov_b64 exec, s[68:69]
    ds_read_b128 a[20:23], v3 offset:9216
    ds_read_b128 a[24:27], v3 offset:9728
    s_mov_b64 exec, -1
    v_exp_f32 v50, v50
    v_exp_f32 v51, v51
    v_exp_f32 v52, v52
    v_mfma_f32_32x32x16_bf16 v[64:79], a[28:31], a[4:7], v[32:47]
    v_exp_f32 v53, v53
    v_exp_f32 v54, v54
    v_exp_f32 v55, v55
    v_exp_f32 v56, v56
    v_exp_f32 v57, v57
    v_smfmac_f32_32x32x32_bf16 v[80:95], a[32:35], v[48:55], v4
    v_exp_f32 v58, v58
    v_exp_f32 v59, v59
    v_exp_f32 v60, v60
    v_exp_f32 v61, v61
    v_exp_f32 v62, v62
    v_exp_f32 v63, v63
    v_exp_f32 v64, v64
    v_exp_f32 v65, v65
    v_smfmac_f32_32x32x32_bf16 v[80:95], a[36:39], v[56:63], v4
    v_exp_f32 v66, v66
    v_exp_f32 v67, v67
    v_exp_f32 v68, v68
    s_waitcnt lgkmcnt(0)
    v_mfma_f32_32x32x16_bf16 v[48:63], a[16:19], a[0:3], v[16:31]
    v_exp_f32 v69, v69
    v_exp_f32 v70, v70
    v_exp_f32 v71, v71
    v_exp_f32 v72, v72
    v_exp_f32 v73, v73
    v_smfmac_f32_32x32x32_bf16 v[96:111], a[32:35], v[64:71], v4
    v_exp_f32 v74, v74
    v_exp_f32 v75, v75
    v_exp_f32 v76, v76
    v_exp_f32 v77, v77
    v_exp_f32 v78, v78
    v_exp_f32 v79, v79
    s_cmp_eq_u32 s56, 2
    s_cbranch_scc0 L_pr_3
    s_setprio 0
L_pr_3:
    v_exp_f32 v48, v48
    v_exp_f32 v49, v49
    v_smfmac_f32_32x32x32_bf16 v[96:111], a[36:39], v[72:79], v4
    ds_read_b128 a[28:31], v2 offset:10240
    s_mov_b64 exec, s[68:69]
    ds_read_b128 a[32:35], v3 offset:11264
    ds_read_b128 a[36:39], v3 offset:11776
    s_mov_b64 exec, -1
    v_exp_f32 v50, v50
    v_exp_f32 v51, v51
    v_exp_f32 v52, v52
    v_mfma_f32_32x32x16_bf16 v[64:79], a[16:19], a[4:7], v[32:47]
    v_exp_f32 v53, v53
    v_exp_f32 v54, v54
    v_exp_f32 v55, v55
    v_exp_f32 v56, v56
    v_exp_f32 v57, v57
    v_smfmac_f32_32x32x32_bf16 v[80:95], a[20:23], v[48:55], v4
    v_exp_f32 v58, v58
    v_exp_f32 v59, v59
    v_exp_f32 v60, v60
    v_exp_f32 v61, v61
    v_exp_f32 v62, v62
    v_exp_f32 v63, v63
    v_exp_f32 v64, v64
    v_exp_f32 v65, v65
    v_smfmac_f32_32x32x32_bf16 v[80:95], a[24:27], v[56:63], v4
    v_exp_f32 v66, v66
    v_exp_f32 v67, v67
    v_exp_f32 v68, v68
    s_waitcnt lgkmcnt(0)
    v_mfma_f32_32x32x16_bf16 v[48:63], a[28:31], a[0:3], v[16:31]
    v_exp_f32 v69, v69
    v_exp_f32 v70, v70
    v_exp_f32 v71, v71
    v_exp_f32 v72, v72
    v_exp_f32 v73, v73
    v_smfmac_f32_32x32x32_bf16 v[96:111], a[20:23], v[64:71], v4
    v_exp_f32 v74, v74
    v_exp_f32 v75, v75
    v_exp_f32 v76, v76
    v_exp_f32 v77, v77
    v_exp_f32 v78, v78
    v_exp_f32 v79, v79
    v_exp_f32 v48, v48
    v_exp_f32 v49, v49
    v_smfmac_f32_32x32x32_bf16 v[96:111], a[24:27], v[72:79], v4
    s_cmp_eq_u32 s59, 0
    s_cbranch_scc1 L_hookd
L_back5:
    ds_read_b128 a[16:19], v2 offset:12288
    s_mov_b64 exec, s[68:69]
    ds_read_b128 a[20:23], v3 offset:13312
    ds_read_b128 a[24:27], v3 offset:13824
    s_mov_b64 exec, -1
    v_exp_f32 v50, v50
    v_exp_f32 v51, v51
    v_exp_f32 v52, v52
    v_mfma_f32_32x32x16_bf16 v[64:79], a[28:31], a[4:7], v[32:47]
    v_exp_f32 v53, v53
    v_exp_f32 v54, v54
    v_exp_f32 v55, v55
    v_exp_f32 v56, v56
    v_exp_f32 v57, v57
    v_smfmac_f32_32x32x32_bf16 v[80:95], a[32:35], v[48:55], v4
    v_exp_f32 v58, v58
    v_exp_f32 v59, v59
    v_exp_f32 v60, v60
    v_exp_f32 v61, v61
    v_exp_f32 v62, v62
    v_exp_f32 v63, v63
    v_exp_f32 v64, v64
    v_exp_f32 v65, v65
    v_smfmac_f32_32x32x32_bf16 v[80:95], a[36:39], v[56:63], v4
    v_exp_f32 v66, v66
    v_exp_f32 v67, v67
    v_exp_f32 v68, v68
    s_waitcnt lgkmcnt(0)
    v_mfma_f32_32x32x16_bf16 v[48:63], a[16:19], a[0:3], v[16:31]
    v_exp_f32 v69, v69
    v_exp_f32 v70, v70
    v_exp_f32 v71, v71
    v_exp_f32 v72, v72
    v_exp_f32 v73, v73
    v_smfmac_f32_32x32x32_bf16 v[96:111], a[32:35], v[64:71], v4
    v_exp_f32 v74, v74
    v_exp_f32 v75, v75
    v_exp_f32 v76, v76
    v_exp_f32 v77, v77
    v_exp_f32 v78, v78
    v_exp_f32 v79, v79
    s_cmp_eq_u32 s56, 0
    s_cbranch_scc0 L_pr_4
    s_setprio 0
L_pr_4:
    v_exp_f32 v48, v48
    v_exp_f32 v49, v49
    v_smfmac_f32_32x32x32_bf16 v[96:111], a[36:39], v[72:79], v4
    ds_read_b128 a[28:31], v2 offset:14336
    s_mov_b64 exec, s[68:69]
    ds_read_b128 a[32:35], v3 offset:15360
    ds_read_b128 a[36:39], v3 offset:15872
    s_mov_b64 exec, -1
    v_exp_f32 v50, v50
    v_exp_f32 v51, v51
    v_exp_f32 v52, v52
    v_mfma_f32_32x32x16_bf16 v[64:79], a[16:19], a[4:7], v[32:47]
    v_exp_f32 v53, v53
    v_exp_f32 v54, v54
    v_exp_f32 v55, v55
    v_exp_f32 v56, v56
    v_exp_f32 v57, v57
    v_smfmac_f32_32x32x32_bf16 v[80:95], a[20:23], v[48:55], v4
    v_exp_f32 v58, v58
    v_exp_f32 v59, v59
    v_exp_f32 v60, v60
    v_exp_f32 v61, v61
    v_exp_f32 v62, v62
    v_exp_f32 v63, v63
    v_exp_f32 v64, v64
    v_exp_f32 v65, v65
    v_smfmac_f32_32x32x32_bf16 v[80:95], a[24:27], v[56:63], v4
    v_exp_f32 v66, v66
    v_exp_f32 v67, v67
    v_exp_f32 v68, v68
    s_waitcnt lgkmcnt(0)
    v_mfma_f32_32x32x16_bf16 v[48:63], a[28:31], a[0:3], v[16:31]
    v_exp_f32 v69, v69
    v_exp_f32 v70, v70
    v_exp_f32 v71, v71
    v_exp_f32 v72, v72
    v_exp_f32 v73, v73
    v_smfmac_f32_32x32x32_bf16 v[96:111], a[20:23], v[64:71], v4
    v_exp_f32 v74, v74
    v_exp_f32 v75, v75
    v_exp_f32 v76, v76
    v_exp_f32 v77, v77
    v_exp_f32 v78, v78
    v_exp_f32 v79, v79
    s_cmp_eq_u32 s56, 0
    s_cbranch_scc0 L_pr_5
    s_setprio 2
L_pr_5:
    s_cmp_eq_u32 s56, 2
    s_cbranch_scc0 L_pr_6
    s_setprio 2
L_pr_6:
    v_exp_f32 v48, v48
    v_exp_f32 v49, v49
    v_smfmac_f32_32x32x32_bf16 v[96:111], a[24:27], v[72:79], v4
    s_cmp_eq_u32 s59, 0
    s_cbranch_scc1 L_hook0
    s_branch L_hook3
L_back7:
    ds_read_b128 a[16:19], v2 offset:16384
    s_mov_b64 exec, s[68:69]
    ds_read_b128 a[20:23], v3 offset:17408
    ds_read_b128 a[24:27], v3 offset:17920
    s_mov_b64 exec, -1
    v_exp_f32 v50, v50
    v_exp_f32 v51, v51
    v_exp_f32 v52, v52
    v_mfma_f32_32x32x16_bf16 v[64:79], a[28:31], a[4:7], v[32:47]
    v_exp_f32 v53, v53
    v_exp_f32 v54, v54
    v_exp_f32 v55, v55
    v_exp_f32 v56, v56
    v_exp_f32 v57, v57
    v_smfmac_f32_32x32x32_bf16 v[80:95], a[32:35], v[48:55], v4
    s_cmp_eq_u32 s59, 0
    s_cbranch_scc1 L_nowo_7
    s_lshl_b32 s58, s52, 12
    s_add_u32 m0, s58, 131072
    s_add_u32 s57, s24, 0
    buffer_load_dwordx4 v192, s[16:19], s57 offen offset:0 lds
    buffer_load_dwordx4 v193, s[16:19], s57 offen offset:1024 lds
L_nowo_7:
    v_exp_f32 v58, v58
    v_exp_f32 v59, v59
    v_exp_f32 v60, v60
    v_exp_f32 v61, v61
    v_exp_f32 v62, v62
    v_exp_f32 v63, v63
    v_exp_f32 v64, v64
    v_exp_f32 v65, v65
    v_smfmac_f32_32x32x32_bf16 v[80:95], a[36:39], v[56:63], v4
    v_exp_f32 v66, v66
    v_exp_f32 v67, v67
    v_exp_f32 v68, v68
    s_waitcnt lgkmcnt(0)
    v_mfma_f32_32x32x16_bf16 v[48:63], a[16:19], a[0:3], v[16:31]
    v_exp_f32 v69, v69
    v_exp_f32 v70, v70
    v_exp_f32 v71, v71
    v_exp_f32 v72, v72
    v_exp_f32 v73, v73
    v_smfmac_f32_32x32x32_bf16 v[96:111], a[32:35], v[64:71], v4
    s_cmp_eq_u32 s59, 0
    s_cbranch_scc1 L_nowo_8
    buffer_load_dwordx4 v194, s[16:19], s57 offen offset:2048 lds
    buffer_load_dwordx4 v195, s[16:19], s57 offen offset:3072 lds
L_nowo_8:
    v_exp_f32 v74, v74
    v_exp_f32 v75, v75
    v_exp_f32 v76, v76
    v_exp_f32 v77, v77
    v_exp_f32 v78, v78
    v_exp_f32 v79, v79
    v_exp_f32 v48, v48
    v_exp_f32 v49, v49
    v_smfmac_f32_32x32x32_bf16 v[96:111], a[36:39], v[72:79], v4
    ds_read_b128 a[28:31], v2 offset:18432
    s_mov_b64 exec, s[68:69]
    ds_read_b128 a[32:35], v3 offset:19456
    ds_read_b128 a[36:39], v3 offset:19968
    s_mov_b64 exec, -1
    v_exp_f32 v50, v50
    v_exp_f32 v51, v51
    v_exp_f32 v52, v52
    v_mfma_f32_32x32x16_bf16 v[64:79], a[16:19], a[4:7], v[32:47]
    v_exp_f32 v53, v53
    v_exp_f32 v54, v54
    v_exp_f32 v55, v55
    v_exp_f32 v56, v56
    v_exp_f32 v57, v57
    v_smfmac_f32_32x32x32_bf16 v[80:95], a[20:23], v[48:55], v4
    v_exp_f32 v58, v58
    v_exp_f32 v59, v59
    v_exp_f32 v60, v60
    v_exp_f32 v61, v61
    v_exp_f32 v62, v62
    v_exp_f32 v63, v63
    v_exp_f32 v64, v64
    v_exp_f32 v65, v65
    v_smfmac_f32_32x32x32_bf16 v[80:95], a[24:27], v[56:63], v4
    v_exp_f32 v66, v66
    v_exp_f32 v67, v67
    v_exp_f32 v68, v68
    s_waitcnt lgkmcnt(0)
    v_mfma_f32_32x32x16_bf16 v[48:63], a[28:31], a[0:3], v[16:31]
    v_exp_f32 v69, v69
    v_exp_f32 v70, v70
    v_exp_f32 v71, v71
    v_exp_f32 v72, v72
    v_exp_f32 v73, v73
    v_smfmac_f32_32x32x32_bf16 v[96:111], a[20:23], v[64:71], v4
    v_exp_f32 v74, v74
    v_exp_f32 v75, v75
    v_exp_f32 v76, v76
    v_exp_f32 v77, v77
    v_exp_f32 v78, v78
    v_exp_f32 v79, v79
    v_exp_f32 v48, v48
    v_exp_f32 v49, v49
    v_smfmac_f32_32x32x32_bf16 v[96:111], a[24:27], v[72:79], v4
    s_cmp_eq_u32 s59, 0
    s_cbranch_scc1 L_hookp
    s_branch L_hook3a
L_back9:
    ds_read_b128 a[16:19], v2 offset:20480
    s_mov_b64 exec, s[68:69]
    ds_read_b128 a[20:23], v3 offset:21504
    ds_read_b128 a[24:27], v3 offset:22016
    s_mov_b64 exec, -1
    v_exp_f32 v50, v50
    v_exp_f32 v51, v51
    v_exp_f32 v52, v52
    v_mfma_f32_32x32x16_bf16 v[64:79], a[28:31], a[4:7], v[32:47]
    v_exp_f32 v53, v53
    v_exp_f32 v54, v54
    v_exp_f32 v55, v55
    v_exp_f32 v56, v56
    v_exp_f32 v57, v57
    v_smfmac_f32_32x32x32_bf16 v[80:95], a[32:35], v[48:55], v4
    v_exp_f32 v58, v58
    v_exp_f32 v59, v59
    v_exp_f32 v60, v60
    v_exp_f32 v61, v61
    v_exp_f32 v62, v62
    v_exp_f32 v63, v63
    v_exp_f32 v64, v64
    v_exp_f32 v65, v65
    v_smfmac_f32_32x32x32_bf16 v[80:95], a[36:39], v[56:63], v4
    v_exp_f32 v66, v66
    v_exp_f32 v67, v67
    v_exp_f32 v68, v68
    s_waitcnt lgkmcnt(0)
    v_mfma_f32_32x32x16_bf16 v[48:63], a[16:19], a[0:3], v[16:31]
    v_exp_f32 v69, v69
    v_exp_f32 v70, v70
    v_exp_f32 v71, v71
    v_exp_f32 v72, v72
    v_exp_f32 v73, v73
    v_smfmac_f32_32x32x32_bf16 v[96:111], a[32:35], v[64:71], v4
    v_exp_f32 v74, v74
    v_exp_f32 v75, v75
    v_exp_f32 v76, v76
    v_exp_f32 v77, v77
    v_exp_f32 v78, v78
    v_exp_f32 v79, v79
    v_exp_f32 v48, v48
    v_exp_f32 v49, v49
    v_smfmac_f32_32x32x32_bf16 v[96:111], a[36:39], v[72:79], v4
    ds_read_b128 a[28:31], v2 offset:22528
    s_mov_b64 exec, s[68:69]
    ds_read_b128 a[32:35], v3 offset:23552
    ds_read_b128 a[36:39], v3 offset:24064
    s_mov_b64 exec, -1
    v_exp_f32 v50, v50
    v_exp_f32 v51, v51
    v_exp_f32 v52, v52
    v_mfma_f32_32x32x16_bf16 v[64:79], a[16:19], a[4:7], v[32:47]
    v_exp_f32 v53, v53
    v_exp_f32 v54, v54
    v_exp_f32 v55, v55
    v_exp_f32 v56, v56
    v_exp_f32 v57, v57
    v_smfmac_f32_32x32x32_bf16 v[80:95], a[20:23], v[48:55], v4
    v_exp_f32 v58, v58
    v_exp_f32 v59, v59
    v_exp_f32 v60, v60
    v_exp_f32 v61, v61
    v_exp_f32 v62, v62
    v_exp_f32 v63, v63
    v_exp_f32 v64, v64
    v_exp_f32 v65, v65
    v_smfmac_f32_32x32x32_bf16 v[80:95], a[24:27], v[56:63], v4
    v_exp_f32 v66, v66
    v_exp_f32 v67, v67
    v_exp_f32 v68, v68
    s_waitcnt lgkmcnt(0)
    v_mfma_f32_32x32x16_bf16 v[48:63], a[28:31], a[0:3], v[16:31]
    v_exp_f32 v69, v69
    v_exp_f32 v70, v70
    v_exp_f32 v71, v71
    v_exp_f32 v72, v72
    v_exp_f32 v73, v73
    v_smfmac_f32_32x32x32_bf16 v[96:111], a[20:23], v[64:71], v4
    v_exp_f32 v74, v74
    v_exp_f32 v75, v75
    v_exp_f32 v76, v76
    v_exp_f32 v77, v77
    v_exp_f32 v78, v78
    v_exp_f32 v79, v79
    v_exp_f32 v48, v48
    v_exp_f32 v49, v49
    v_smfmac_f32_32x32x32_bf16 v[96:111], a[24:27], v[72:79], v4
    ds_read_b128 a[16:19], v2 offset:24576
    s_mov_b64 exec, s[68:69]
    ds_read_b128 a[20:23], v3 offset:25600
    ds_read_b128 a[24:27], v3 offset:26112
    s_mov_b64 exec, -1
    v_exp_f32 v50, v50
    v_exp_f32 v51, v51
    v_exp_f32 v52, v52
    v_mfma_f32_32x32x16_bf16 v[64:79], a[28:31], a[4:7], v[32:47]
    v_exp_f32 v53, v53
    v_exp_f32 v54, v54
    v_exp_f32 v55, v55
    v_exp_f32 v56, v56
    v_exp_f32 v57, v57
    v_smfmac_f32_32x32x32_bf16 v[80:95], a[32:35], v[48:55], v4
    v_exp_f32 v58, v58
    v_exp_f32 v59, v59
    v_exp_f32 v60, v60
    v_exp_f32 v61, v61
    v_exp_f32 v62, v62
    v_exp_f32 v63, v63
    v_exp_f32 v64, v64
    v_exp_f32 v65, v65
    v_smfmac_f32_32x32x32_bf16 v[80:95], a[36:39], v[56:63], v4
    v_exp_f32 v66, v66
    v_exp_f32 v67, v67
    v_exp_f32 v68, v68
    s_waitcnt lgkmcnt(0)
    v_mfma_f32_32x32x16_bf16 v[48:63], a[16:19], a[0:3], v[16:31]
    v_exp_f32 v69, v69
    v_exp_f32 v70, v70
    v_exp_f32 v71, v71
    v_exp_f32 v72, v72
    v_exp_f32 v73, v73
    v_smfmac_f32_32x32x32_bf16 v[96:111], a[32:35], v[64:71], v4
    v_exp_f32 v74, v74
    v_exp_f32 v75, v75
    v_exp_f32 v76, v76
    v_exp_f32 v77, v77
    v_exp_f32 v78, v78
    v_exp_f32 v79, v79
    v_exp_f32 v48, v48
    v_exp_f32 v49, v49
    v_smfmac_f32_32x32x32_bf16 v[96:111], a[36:39], v[72:79], v4
    ds_read_b128 a[28:31], v2 offset:26624
    s_mov_b64 exec, s[68:69]
    ds_read_b128 a[32:35], v3 offset:27648
    ds_read_b128 a[36:39], v3 offset:28160
    s_mov_b64 exec, -1
    v_exp_f32 v50, v50
    v_exp_f32 v51, v51
    v_exp_f32 v52, v52
    v_mfma_f32_32x32x16_bf16 v[64:79], a[16:19], a[4:7], v[32:47]
    v_exp_f32 v53, v53
    v_exp_f32 v54, v54
    v_exp_f32 v55, v55
    v_exp_f32 v56, v56
    v_exp_f32 v57, v57
    v_smfmac_f32_32x32x32_bf16 v[80:95], a[20:23], v[48:55], v4
    v_exp_f32 v58, v58
    v_exp_f32 v59, v59
    v_exp_f32 v60, v60
    v_exp_f32 v61, v61
    v_exp_f32 v62, v62
    v_exp_f32 v63, v63
    v_exp_f32 v64, v64
    v_exp_f32 v65, v65
    v_smfmac_f32_32x32x32_bf16 v[80:95], a[24:27], v[56:63], v4
    v_exp_f32 v66, v66
    v_exp_f32 v67, v67
    v_exp_f32 v68, v68
    s_waitcnt lgkmcnt(0)
    v_mfma_f32_32x32x16_bf16 v[48:63], a[28:31], a[0:3], v[16:31]
    v_exp_f32 v69, v69
    v_exp_f32 v70, v70
    v_exp_f32 v71, v71
    v_exp_f32 v72, v72
    v_exp_f32 v73, v73
    v_smfmac_f32_32x32x32_bf16 v[96:111], a[20:23], v[64:71], v4
    v_exp_f32 v74, v74
    v_exp_f32 v75, v75
    v_exp_f32 v76, v76
    v_exp_f32 v77, v77
    v_exp_f32 v78, v78
    v_exp_f32 v79, v79
    v_exp_f32 v48, v48
    v_exp_f32 v49, v49
    v_smfmac_f32_32x32x32_bf16 v[96:111], a[24:27], v[72:79], v4
    s_cmp_eq_u32 s59, 0
    s_cbranch_scc1 L_hooks2
    s_branch L_hooks3
L_back13:
    ds_read_b128 a[16:19], v2 offset:28672
    s_mov_b64 exec, s[68:69]
    ds_read_b128 a[20:23], v3 offset:29696
    ds_read_b128 a[24:27], v3 offset:30208
    s_mov_b64 exec, -1
    v_exp_f32 v50, v50
    v_exp_f32 v51, v51
    v_exp_f32 v52, v52
    v_mfma_f32_32x32x16_bf16 v[64:79], a[28:31], a[4:7], v[32:47]
    v_exp_f32 v53, v53
    v_exp_f32 v54, v54
    v_exp_f32 v55, v55
    v_exp_f32 v56, v56
    v_exp_f32 v57, v57
    v_smfmac_f32_32x32x32_bf16 v[80:95], a[32:35], v[48:55], v4
    v_exp_f32 v58, v58
    v_exp_f32 v59, v59
    v_exp_f32 v60, v60
    v_exp_f32 v61, v61
    v_exp_f32 v62, v62
    v_exp_f32 v63, v63
    v_exp_f32 v64, v64
    v_exp_f32 v65, v65
    v_smfmac_f32_32x32x32_bf16 v[80:95], a[36:39], v[56:63], v4
    v_exp_f32 v66, v66
    v_exp_f32 v67, v67
    v_exp_f32 v68, v68
    s_waitcnt lgkmcnt(0)
    v_mfma_f32_32x32x16_bf16 v[48:63], a[16:19], a[0:3], v[16:31]
    v_exp_f32 v69, v69
    v_exp_f32 v70, v70
    v_exp_f32 v71, v71
    v_exp_f32 v72, v72
    v_exp_f32 v73, v73
    v_smfmac_f32_32x32x32_bf16 v[96:111], a[32:35], v[64:71], v4
    v_exp_f32 v74, v74
    v_exp_f32 v75, v75
    v_exp_f32 v76, v76
    v_exp_f32 v77, v77
    v_exp_f32 v78, v78
    v_exp_f32 v79, v79
    v_exp_f32 v48, v48
    v_exp_f32 v49, v49
    v_smfmac_f32_32x32x32_bf16 v[96:111], a[36:39], v[72:79], v4
    ds_read_b128 a[28:31], v2 offset:30720
    s_mov_b64 exec, s[68:69]
    ds_read_b128 a[32:35], v3 offset:31744
    ds_read_b128 a[36:39], v3 offset:32256
    s_mov_b64 exec, -1
    v_exp_f32 v50, v50
    v_exp_f32 v51, v51
    v_exp_f32 v52, v52
    v_mfma_f32_32x32x16_bf16 v[64:79], a[16:19], a[4:7], v[32:47]
    v_exp_f32 v53, v53
    v_exp_f32 v54, v54
    v_exp_f32 v55, v55
    v_exp_f32 v56, v56
    v_exp_f32 v57, v57
    v_smfmac_f32_32x32x32_bf16 v[80:95], a[20:23], v[48:55], v4
    v_exp_f32 v58, v58
    v_exp_f32 v59, v59
    v_exp_f32 v60, v60
    v_exp_f32 v61, v61
    v_exp_f32 v62, v62
    v_exp_f32 v63, v63
    v_exp_f32 v64, v64
    v_exp_f32 v65, v65
    v_smfmac_f32_32x32x32_bf16 v[80:95], a[24:27], v[56:63], v4
    v_exp_f32 v66, v66
    v_exp_f32 v67, v67
    v_exp_f32 v68, v68
    s_waitcnt lgkmcnt(0)
    v_mfma_f32_32x32x16_bf16 v[48:63], a[28:31], a[0:3], v[16:31]
    v_exp_f32 v69, v69
    v_exp_f32 v70, v70
    v_exp_f32 v71, v71
    v_exp_f32 v72, v72
    v_exp_f32 v73, v73
    v_smfmac_f32_32x32x32_bf16 v[96:111], a[20:23], v[64:71], v4
    v_exp_f32 v74, v74
    v_exp_f32 v75, v75
    v_exp_f32 v76, v76
    v_exp_f32 v77, v77
    v_exp_f32 v78, v78
    v_exp_f32 v79, v79
    v_exp_f32 v48, v48
    v_exp_f32 v49, v49
    v_smfmac_f32_32x32x32_bf16 v[96:111], a[24:27], v[72:79], v4
    ds_read_b128 a[16:19], v2 offset:32768
    s_mov_b64 exec, s[68:69]
    ds_read_b128 a[20:23], v3 offset:33792
    ds_read_b128 a[24:27], v3 offset:34304
    s_mov_b64 exec, -1
    v_exp_f32 v50, v50
    v_exp_f32 v51, v51
    v_exp_f32 v52, v52
    v_mfma_f32_32x32x16_bf16 v[64:79], a[28:31], a[4:7], v[32:47]
    v_exp_f32 v53, v53
    v_exp_f32 v54, v54
    v_exp_f32 v55, v55
    v_exp_f32 v56, v56
    v_exp_f32 v57, v57
    v_smfmac_f32_32x32x32_bf16 v[80:95], a[32:35], v[48:55], v4
    v_exp_f32 v58, v58
    v_exp_f32 v59, v59
    v_exp_f32 v60, v60
    v_exp_f32 v61, v61
    v_exp_f32 v62, v62
    v_exp_f32 v63, v63
    s_cmp_eq_u32 s56, 0
    s_cbranch_scc0 L_pr_9
    s_setprio 0
L_pr_9:
    v_exp_f32 v64, v64
    v_exp_f32 v65, v65
    v_smfmac_f32_32x32x32_bf16 v[80:95], a[36:39], v[56:63], v4
    v_exp_f32 v66, v66
    v_exp_f32 v67, v67
    v_exp_f32 v68, v68
    s_waitcnt lgkmcnt(0)
    v_mfma_f32_32x32x16_bf16 v[48:63], a[16:19], a[0:3], v[16:31]
    v_exp_f32 v69, v69
    v_exp_f32 v70, v70
    v_exp_f32 v71, v71
    v_exp_f32 v72, v72
    v_exp_f32 v73, v73
    v_smfmac_f32_32x32x32_bf16 v[96:111], a[32:35], v[64:71], v4
    v_exp_f32 v74, v74
    v_exp_f32 v75, v75
    v_exp_f32 v76, v76
    v_exp_f32 v77, v77
    v_exp_f32 v78, v78
    v_exp_f32 v79, v79
    v_exp_f32 v48, v48
    v_exp_f32 v49, v49
    v_smfmac_f32_32x32x32_bf16 v[96:111], a[36:39], v[72:79], v4
    ds_read_b128 a[28:31], v2 offset:34816
    s_mov_b64 exec, s[68:69]
    ds_read_b128 a[32:35], v3 offset:35840
    ds_read_b128 a[36:39], v3 offset:36352
    s_mov_b64 exec, -1
    v_exp_f32 v50, v50
    v_exp_f32 v51, v51
    v_exp_f32 v52, v52
    v_mfma_f32_32x32x16_bf16 v[64:79], a[16:19], a[4:7], v[32:47]
    v_exp_f32 v53, v53
    v_exp_f32 v54, v54
    v_exp_f32 v55, v55
    v_exp_f32 v56, v56
    v_exp_f32 v57, v57
    v_smfmac_f32_32x32x32_bf16 v[80:95], a[20:23], v[48:55], v4
    v_exp_f32 v58, v58
    v_exp_f32 v59, v59
    v_exp_f32 v60, v60
    v_exp_f32 v61, v61
    v_exp_f32 v62, v62
    v_exp_f32 v63, v63
    v_exp_f32 v64, v64
    v_exp_f32 v65, v65
    v_smfmac_f32_32x32x32_bf16 v[80:95], a[24:27], v[56:63], v4
    v_exp_f32 v66, v66
    v_exp_f32 v67, v67
    v_exp_f32 v68, v68
    s_waitcnt lgkmcnt(0)
    v_mfma_f32_32x32x16_bf16 v[48:63], a[28:31], a[0:3], v[16:31]
    v_exp_f32 v69, v69
    v_exp_f32 v70, v70
    v_exp_f32 v71, v71
    v_exp_f32 v72, v72
    v_exp_f32 v73, v73
    v_smfmac_f32_32x32x32_bf16 v[96:111], a[20:23], v[64:71], v4
    v_exp_f32 v74, v74
    v_exp_f32 v75, v75
    v_exp_f32 v76, v76
    v_exp_f32 v77, v77
    v_exp_f32 v78, v78
    v_exp_f32 v79, v79
    v_exp_f32 v48, v48
    v_exp_f32 v49, v49
    v_smfmac_f32_32x32x32_bf16 v[96:111], a[24:27], v[72:79], v4
    ds_read_b128 a[16:19], v2 offset:36864
    s_mov_b64 exec, s[68:69]
    ds_read_b128 a[20:23], v3 offset:37888
    ds_read_b128 a[24:27], v3 offset:38400
    s_mov_b64 exec, -1
    v_exp_f32 v50, v50
    v_exp_f32 v51, v51
    v_exp_f32 v52, v52
    v_mfma_f32_32x32x16_bf16 v[64:79], a[28:31], a[4:7], v[32:47]
    v_exp_f32 v53, v53
    v_exp_f32 v54, v54
    v_exp_f32 v55, v55
    v_exp_f32 v56, v56
    v_exp_f32 v57, v57
    v_smfmac_f32_32x32x32_bf16 v[80:95], a[32:35], v[48:55], v4
    v_exp_f32 v58, v58
    v_exp_f32 v59, v59
    v_exp_f32 v60, v60
    v_exp_f32 v61, v61
    v_exp_f32 v62, v62
    v_exp_f32 v63, v63
    v_exp_f32 v64, v64
    v_exp_f32 v65, v65
    v_smfmac_f32_32x32x32_bf16 v[80:95], a[36:39], v[56:63], v4
    v_exp_f32 v66, v66
    v_exp_f32 v67, v67
    v_exp_f32 v68, v68
    s_waitcnt lgkmcnt(0)
    v_mfma_f32_32x32x16_bf16 v[48:63], a[16:19], a[0:3], v[16:31]
    v_exp_f32 v69, v69
    v_exp_f32 v70, v70
    v_exp_f32 v71, v71
    v_exp_f32 v72, v72
    v_exp_f32 v73, v73
    v_smfmac_f32_32x32x32_bf16 v[96:111], a[32:35], v[64:71], v4
    v_exp_f32 v74, v74
    v_exp_f32 v75, v75
    v_exp_f32 v76, v76
    v_exp_f32 v77, v77
    v_exp_f32 v78, v78
    v_exp_f32 v79, v79
    v_exp_f32 v48, v48
    v_exp_f32 v49, v49
    v_smfmac_f32_32x32x32_bf16 v[96:111], a[36:39], v[72:79], v4
    ds_read_b128 a[28:31], v2 offset:38912
    s_mov_b64 exec, s[68:69]
    ds_read_b128 a[32:35], v3 offset:39936
    ds_read_b128 a[36:39], v3 offset:40448
    s_mov_b64 exec, -1
    v_exp_f32 v50, v50
    v_exp_f32 v51, v51
    v_exp_f32 v52, v52
    v_mfma_f32_32x32x16_bf16 v[64:79], a[16:19], a[4:7], v[32:47]
    v_exp_f32 v53, v53
    v_exp_f32 v54, v54
    v_exp_f32 v55, v55
    v_exp_f32 v56, v56
    v_exp_f32 v57, v57
    v_smfmac_f32_32x32x32_bf16 v[80:95], a[20:23], v[48:55], v4
    v_exp_f32 v58, v58
    v_exp_f32 v59, v59
    v_exp_f32 v60, v60
    v_exp_f32 v61, v61
    v_exp_f32 v62, v62
    v_exp_f32 v63, v63
    v_exp_f32 v64, v64
    v_exp_f32 v65, v65
    v_smfmac_f32_32x32x32_bf16 v[80:95], a[24:27], v[56:63], v4
    v_exp_f32 v66, v66
    v_exp_f32 v67, v67
    v_exp_f32 v68, v68
    s_waitcnt lgkmcnt(0)
    v_mfma_f32_32x32x16_bf16 v[48:63], a[28:31], a[0:3], v[16:31]
    v_exp_f32 v69, v69
    v_exp_f32 v70, v70
    v_exp_f32 v71, v71
    v_exp_f32 v72, v72
    v_exp_f32 v73, v73
    v_smfmac_f32_32x32x32_bf16 v[96:111], a[20:23], v[64:71], v4
    v_exp_f32 v74, v74
    v_exp_f32 v75, v75
    v_exp_f32 v76, v76
    v_exp_f32 v77, v77
    v_exp_f32 v78, v78
    v_exp_f32 v79, v79
    v_exp_f32 v48, v48
    v_exp_f32 v49, v49
    v_smfmac_f32_32x32x32_bf16 v[96:111], a[24:27], v[72:79], v4
    ds_read_b128 a[16:19], v2 offset:40960
    s_mov_b64 exec, s[68:69]
    ds_read_b128 a[20:23], v3 offset:41984
    ds_read_b128 a[24:27], v3 offset:42496
    s_mov_b64 exec, -1
    v_exp_f32 v50, v50
    v_exp_f32 v51, v51
    v_exp_f32 v52, v52
    v_mfma_f32_32x32x16_bf16 v[64:79], a[28:31], a[4:7], v[32:47]
    v_exp_f32 v53, v53
    v_exp_f32 v54, v54
    v_exp_f32 v55, v55
    v_exp_f32 v56, v56
    v_exp_f32 v57, v57
    v_smfmac_f32_32x32x32_bf16 v[80:95], a[32:35], v[48:55], v4
    v_exp_f32 v58, v58
    v_exp_f32 v59, v59
    v_exp_f32 v60, v60
    v_exp_f32 v61, v61
    v_exp_f32 v62, v62
    v_exp_f32 v63, v63
    v_exp_f32 v64, v64
    v_exp_f32 v65, v65
    v_smfmac_f32_32x32x32_bf16 v[80:95], a[36:39], v[56:63], v4
    v_exp_f32 v66, v66
    v_exp_f32 v67, v67
    v_exp_f32 v68, v68
    s_waitcnt lgkmcnt(0)
    v_mfma_f32_32x32x16_bf16 v[48:63], a[16:19], a[0:3], v[16:31]
    v_exp_f32 v69, v69
    v_exp_f32 v70, v70
    v_exp_f32 v71, v71
    v_exp_f32 v72, v72
    v_exp_f32 v73, v73
    v_smfmac_f32_32x32x32_bf16 v[96:111], a[32:35], v[64:71], v4
    v_exp_f32 v74, v74
    v_exp_f32 v75, v75
    v_exp_f32 v76, v76
    v_exp_f32 v77, v77
    v_exp_f32 v78, v78
    v_exp_f32 v79, v79
    s_cmp_eq_u32 s56, 0
    s_cbranch_scc0 L_pr_10
    s_setprio 2
L_pr_10:
    v_exp_f32 v48, v48
    v_exp_f32 v49, v49
    v_smfmac_f32_32x32x32_bf16 v[96:111], a[36:39], v[72:79], v4
    ds_read_b128 a[28:31], v2 offset:43008
    s_mov_b64 exec, s[68:69]
    ds_read_b128 a[32:35], v3 offset:44032
    ds_read_b128 a[36:39], v3 offset:44544
    s_mov_b64 exec, -1
    v_exp_f32 v50, v50
    v_exp_f32 v51, v51
    v_exp_f32 v52, v52
    v_mfma_f32_32x32x16_bf16 v[64:79], a[16:19], a[4:7], v[32:47]
    v_exp_f32 v53, v53
    v_exp_f32 v54, v54
    v_exp_f32 v55, v55
    v_exp_f32 v56, v56
    v_exp_f32 v57, v57
    v_smfmac_f32_32x32x32_bf16 v[80:95], a[20:23], v[48:55], v4
    v_exp_f32 v58, v58
    v_exp_f32 v59, v59
    v_exp_f32 v60, v60
    v_exp_f32 v61, v61
    v_exp_f32 v62, v62
    v_exp_f32 v63, v63
    s_cmp_eq_u32 s56, 2
    s_cbranch_scc0 L_pr_11
    s_setprio 0
L_pr_11:
    v_exp_f32 v64, v64
    v_exp_f32 v65, v65
    v_smfmac_f32_32x32x32_bf16 v[80:95], a[24:27], v[56:63], v4
    v_exp_f32 v66, v66
    v_exp_f32 v67, v67
    v_exp_f32 v68, v68
    s_waitcnt lgkmcnt(0)
    v_mfma_f32_32x32x16_bf16 v[48:63], a[28:31], a[0:3], v[16:31]
    v_exp_f32 v69, v69
    v_exp_f32 v70, v70
    v_exp_f32 v71, v71
    v_exp_f32 v72, v72
    v_exp_f32 v73, v73
    v_smfmac_f32_32x32x32_bf16 v[96:111], a[20:23], v[64:71], v4
    v_exp_f32 v74, v74
    v_exp_f32 v75, v75
    v_exp_f32 v76, v76
    v_exp_f32 v77, v77
    v_exp_f32 v78, v78
    v_exp_f32 v79, v79
    v_exp_f32 v48, v48
    v_exp_f32 v49, v49
    v_smfmac_f32_32x32x32_bf16 v[96:111], a[24:27], v[72:79], v4
    ds_read_b128 a[16:19], v2 offset:45056
    s_mov_b64 exec, s[68:69]
    ds_read_b128 a[20:23], v3 offset:46080
    ds_read_b128 a[24:27], v3 offset:46592
    s_mov_b64 exec, -1
    v_exp_f32 v50, v50
    v_exp_f32 v51, v51
    v_exp_f32 v52, v52
    v_mfma_f32_32x32x16_bf16 v[64:79], a[28:31], a[4:7], v[32:47]
    v_exp_f32 v53, v53
    v_exp_f32 v54, v54
    v_exp_f32 v55, v55
    v_exp_f32 v56, v56
    v_exp_f32 v57, v57
    v_smfmac_f32_32x32x32_bf16 v[80:95], a[32:35], v[48:55], v4
    v_exp_f32 v58, v58
    v_exp_f32 v59, v59
    v_exp_f32 v60, v60
    v_exp_f32 v61, v61
    v_exp_f32 v62, v62
    v_exp_f32 v63, v63
    v_exp_f32 v64, v64
    v_exp_f32 v65, v65
    v_smfmac_f32_32x32x32_bf16 v[80:95], a[36:39], v[56:63], v4
    v_exp_f32 v66, v66
    v_exp_f32 v67, v67
    v_exp_f32 v68, v68
    s_waitcnt lgkmcnt(0)
    v_mfma_f32_32x32x16_bf16 v[48:63], a[16:19], a[0:3], v[16:31]
    v_exp_f32 v69, v69
    v_exp_f32 v70, v70
    v_exp_f32 v71, v71
    v_exp_f32 v72, v72
    v_exp_f32 v73, v73
    v_smfmac_f32_32x32x32_bf16 v[96:111], a[32:35], v[64:71], v4
    v_exp_f32 v74, v74
    v_exp_f32 v75, v75
    v_exp_f32 v76, v76
    v_exp_f32 v77, v77
    v_exp_f32 v78, v78
    v_exp_f32 v79, v79
    v_exp_f32 v48, v48
    v_exp_f32 v49, v49
    v_smfmac_f32_32x32x32_bf16 v[96:111], a[36:39], v[72:79], v4
    ds_read_b128 a[28:31], v2 offset:47104
    s_mov_b64 exec, s[68:69]
    ds_read_b128 a[32:35], v3 offset:48128
    ds_read_b128 a[36:39], v3 offset:48640
    s_mov_b64 exec, -1
    v_exp_f32 v50, v50
    v_exp_f32 v51, v51
    v_exp_f32 v52, v52
    v_mfma_f32_32x32x16_bf16 v[64:79], a[16:19], a[4:7], v[32:47]
    v_exp_f32 v53, v53
    v_exp_f32 v54, v54
    v_exp_f32 v55, v55
    v_exp_f32 v56, v56
    v_exp_f32 v57, v57
    v_smfmac_f32_32x32x32_bf16 v[80:95], a[20:23], v[48:55], v4
    v_exp_f32 v58, v58
    v_exp_f32 v59, v59
    v_exp_f32 v60, v60
    v_exp_f32 v61, v61
    v_exp_f32 v62, v62
    v_exp_f32 v63, v63
    v_exp_f32 v64, v64
    v_exp_f32 v65, v65
    v_smfmac_f32_32x32x32_bf16 v[80:95], a[24:27], v[56:63], v4
    v_exp_f32 v66, v66
    v_exp_f32 v67, v67
    v_exp_f32 v68, v68
    s_waitcnt lgkmcnt(0)
    v_mfma_f32_32x32x16_bf16 v[48:63], a[28:31], a[0:3], v[16:31]
    v_exp_f32 v69, v69
    v_exp_f32 v70, v70
    v_exp_f32 v71, v71
    v_exp_f32 v72, v72
    v_exp_f32 v73, v73
    v_smfmac_f32_32x32x32_bf16 v[96:111], a[20:23], v[64:71], v4
    v_exp_f32 v74, v74
    v_exp_f32 v75, v75
    v_exp_f32 v76, v76
    v_exp_f32 v77, v77
    v_exp_f32 v78, v78
    v_exp_f32 v79, v79
    v_exp_f32 v48, v48
    v_exp_f32 v49, v49
    v_smfmac_f32_32x32x32_bf16 v[96:111], a[24:27], v[72:79], v4
    s_cmp_eq_u32 s59, 0
    s_cbranch_scc1 L_hook1
    s_branch L_hook6
L_back23:
    ds_read_b128 a[16:19], v2 offset:49152
    s_mov_b64 exec, s[68:69]
    ds_read_b128 a[20:23], v3 offset:50176
    ds_read_b128 a[24:27], v3 offset:50688
    s_mov_b64 exec, -1
    v_exp_f32 v50, v50
    v_exp_f32 v51, v51
    v_exp_f32 v52, v52
    v_mfma_f32_32x32x16_bf16 v[64:79], a[28:31], a[4:7], v[32:47]
    v_exp_f32 v53, v53
    v_exp_f32 v54, v54
    v_exp_f32 v55, v55
    v_exp_f32 v56, v56
    v_exp_f32 v57, v57
    v_smfmac_f32_32x32x32_bf16 v[80:95], a[32:35], v[48:55], v4
    s_cmp_eq_u32 s59, 0
    s_cbranch_scc1 L_nowo_12
    s_add_u32 m0, s25, 0
    s_add_u32 s57, s24, 262144
    buffer_load_dwordx4 v192, s[16:19], s57 offen offset:0 lds
    buffer_load_dwordx4 v193, s[16:19], s57 offen offset:1024 lds
L_nowo_12:
    v_exp_f32 v58, v58
    v_exp_f32 v59, v59
    v_exp_f32 v60, v60
    v_exp_f32 v61, v61
    v_exp_f32 v62, v62
    v_exp_f32 v63, v63
    s_cmp_eq_u32 s56, 2
    s_cbranch_scc0 L_pr_13
    s_setprio 2
L_pr_13:
    v_exp_f32 v64, v64
    v_exp_f32 v65, v65
    v_smfmac_f32_32x32x32_bf16 v[80:95], a[36:39], v[56:63], v4
    v_exp_f32 v66, v66
    v_exp_f32 v67, v67
    v_exp_f32 v68, v68
    s_waitcnt lgkmcnt(0)
    v_mfma_f32_32x32x16_bf16 v[48:63], a[16:19], a[0:3], v[16:31]
    v_exp_f32 v69, v69
    v_exp_f32 v70, v70
    v_exp_f32 v71, v71
    v_exp_f32 v72, v72
    v_exp_f32 v73, v73
    v_smfmac_f32_32x32x32_bf16 v[96:111], a[32:35], v[64:71], v4
    s_cmp_eq_u32 s59, 0
    s_cbranch_scc1 L_nowo_14
    buffer_load_dwordx4 v194, s[16:19], s57 offen offset:2048 lds
    buffer_load_dwordx4 v195, s[16:19], s57 offen offset:3072 lds
L_nowo_14:
    v_exp_f32 v74, v74
    v_exp_f32 v75, v75
    v_exp_f32 v76, v76
    v_exp_f32 v77, v77
    v_exp_f32 v78, v78
    v_exp_f32 v79, v79
    v_exp_f32 v48, v48
    v_exp_f32 v49, v49
    v_smfmac_f32_32x32x32_bf16 v[96:111], a[36:39], v[72:79], v4
    ds_read_b128 a[28:31], v2 offset:51200
    s_mov_b64 exec, s[68:69]
    ds_read_b128 a[32:35], v3 offset:52224
    ds_read_b128 a[36:39], v3 offset:52736
    s_mov_b64 exec, -1
    v_exp_f32 v50, v50
    v_exp_f32 v51, v51
    v_exp_f32 v52, v52
    v_mfma_f32_32x32x16_bf16 v[64:79], a[16:19], a[4:7], v[32:47]
    v_exp_f32 v53, v53
    v_exp_f32 v54, v54
    v_exp_f32 v55, v55
    v_exp_f32 v56, v56
    v_exp_f32 v57, v57
    v_smfmac_f32_32x32x32_bf16 v[80:95], a[20:23], v[48:55], v4
    s_cmp_eq_u32 s59, 0
    s_cbranch_scc1 L_nowo_15
    s_add_u32 m0, s27, 0
    s_add_u32 s57, s26, 0
    buffer_load_dwordx4 v192, s[12:15], s57 offen offset:0 lds
    buffer_load_dwordx4 v193, s[12:15], s57 offen offset:1024 lds
L_nowo_15:
    v_exp_f32 v58, v58
    v_exp_f32 v59, v59
    v_exp_f32 v60, v60
    v_exp_f32 v61, v61
    v_exp_f32 v62, v62
    v_exp_f32 v63, v63
    v_exp_f32 v64, v64
    v_exp_f32 v65, v65
    v_smfmac_f32_32x32x32_bf16 v[80:95], a[24:27], v[56:63], v4
    v_exp_f32 v66, v66
    v_exp_f32 v67, v67
    v_exp_f32 v68, v68
    s_waitcnt lgkmcnt(0)
    v_mfma_f32_32x32x16_bf16 v[48:63], a[28:31], a[0:3], v[16:31]
    v_exp_f32 v69, v69
    v_exp_f32 v70, v70
    v_exp_f32 v71, v71
    v_exp_f32 v72, v72
    v_exp_f32 v73, v73
    v_smfmac_f32_32x32x32_bf16 v[96:111], a[20:23], v[64:71], v4
    s_cmp_eq_u32 s59, 0
    s_cbranch_scc1 L_nowo_16
    buffer_load_dwordx4 v194, s[12:15], s57 offen offset:2048 lds
    buffer_load_dwordx4 v195, s[12:15], s57 offen offset:3072 lds
L_nowo_16:
    v_exp_f32 v74, v74
    v_exp_f32 v75, v75
    v_exp_f32 v76, v76
    v_exp_f32 v77, v77
    v_exp_f32 v78, v78
    v_exp_f32 v79, v79
    v_exp_f32 v48, v48
    v_exp_f32 v49, v49
    v_smfmac_f32_32x32x32_bf16 v[96:111], a[24:27], v[72:79], v4
    s_cmp_eq_u32 s59, 0
    s_cbranch_scc1 L_hook2
    s_branch L_hook5
L_back25:
    ds_read_b128 a[16:19], v2 offset:53248
    s_mov_b64 exec, s[68:69]
    ds_read_b128 a[20:23], v3 offset:54272
    ds_read_b128 a[24:27], v3 offset:54784
    s_mov_b64 exec, -1
    v_exp_f32 v50, v50
    v_exp_f32 v51, v51
    v_exp_f32 v52, v52
    v_mfma_f32_32x32x16_bf16 v[64:79], a[28:31], a[4:7], v[32:47]
    v_exp_f32 v53, v53
    v_exp_f32 v54, v54
    v_exp_f32 v55, v55
    v_exp_f32 v56, v56
    v_exp_f32 v57, v57
    v_smfmac_f32_32x32x32_bf16 v[80:95], a[32:35], v[48:55], v4
    s_cmp_eq_u32 s59, 0
    s_cbranch_scc1 L_nowo_17
    s_add_u32 m0, s27, 4096
    s_add_u32 s57, s26, 32768
    buffer_load_dwordx4 v192, s[12:15], s57 offen offset:0 lds
    buffer_load_dwordx4 v193, s[12:15], s57 offen offset:1024 lds
L_nowo_17:
    v_exp_f32 v58, v58
    v_exp_f32 v59, v59
    v_exp_f32 v60, v60
    v_exp_f32 v61, v61
    v_exp_f32 v62, v62
    v_exp_f32 v63, v63
    v_exp_f32 v64, v64
    v_exp_f32 v65, v65
    v_smfmac_f32_32x32x32_bf16 v[80:95], a[36:39], v[56:63], v4
    v_exp_f32 v66, v66
    v_exp_f32 v67, v67
    v_exp_f32 v68, v68
    s_waitcnt lgkmcnt(0)
    v_mfma_f32_32x32x16_bf16 v[48:63], a[16:19], a[0:3], v[16:31]
    v_exp_f32 v69, v69
    v_exp_f32 v70, v70
    v_exp_f32 v71, v71
    v_exp_f32 v72, v72
    v_exp_f32 v73, v73
    v_smfmac_f32_32x32x32_bf16 v[96:111], a[32:35], v[64:71], v4
    s_cmp_eq_u32 s59, 0
    s_cbranch_scc1 L_nowo_18
    buffer_load_dwordx4 v194, s[12:15], s57 offen offset:2048 lds
    buffer_load_dwordx4 v195, s[12:15], s57 offen offset:3072 lds
L_nowo_18:
    v_exp_f32 v74, v74
    v_exp_f32 v75, v75
    v_exp_f32 v76, v76
    v_exp_f32 v77, v77
    v_exp_f32 v78, v78
    v_exp_f32 v79, v79
    v_exp_f32 v48, v48
    v_exp_f32 v49, v49
    v_smfmac_f32_32x32x32_bf16 v[96:111], a[36:39], v[72:79], v4
    ds_read_b128 a[28:31], v2 offset:55296
    s_mov_b64 exec, s[68:69]
    ds_read_b128 a[32:35], v3 offset:56320
    ds_read_b128 a[36:39], v3 offset:56832
    s_mov_b64 exec, -1
    v_exp_f32 v50, v50
    v_exp_f32 v51, v51
    v_exp_f32 v52, v52
    v_mfma_f32_32x32x16_bf16 v[64:79], a[16:19], a[4:7], v[32:47]
    v_exp_f32 v53, v53
    v_exp_f32 v54, v54
    v_exp_f32 v55, v55
    v_exp_f32 v56, v56
    v_exp_f32 v57, v57
    v_smfmac_f32_32x32x32_bf16 v[80:95], a[20:23], v[48:55], v4
    v_exp_f32 v58, v58
    v_exp_f32 v59, v59
    v_exp_f32 v60, v60
    v_exp_f32 v61, v61
    v_exp_f32 v62, v62
    v_exp_f32 v63, v63
    v_exp_f32 v64, v64
    v_exp_f32 v65, v65
    v_smfmac_f32_32x32x32_bf16 v[80:95], a[24:27], v[56:63], v4
    v_exp_f32 v66, v66
    v_exp_f32 v67, v67
    v_exp_f32 v68, v68
    s_waitcnt lgkmcnt(0)
    v_mfma_f32_32x32x16_bf16 v[48:63], a[28:31], a[0:3], v[16:31]
    v_exp_f32 v69, v69
    v_exp_f32 v70, v70
    v_exp_f32 v71, v71
    v_exp_f32 v72, v72
    v_exp_f32 v73, v73
    v_smfmac_f32_32x32x32_bf16 v[96:111], a[20:23], v[64:71], v4
    v_exp_f32 v74, v74
    v_exp_f32 v75, v75
    v_exp_f32 v76, v76
    v_exp_f32 v77, v77
    v_exp_f32 v78, v78
    v_exp_f32 v79, v79
    v_exp_f32 v48, v48
    v_exp_f32 v49, v49
    v_smfmac_f32_32x32x32_bf16 v[96:111], a[24:27], v[72:79], v4
    ds_read_b128 a[16:19], v2 offset:57344
    s_mov_b64 exec, s[68:69]
    ds_read_b128 a[20:23], v3 offset:58368
    ds_read_b128 a[24:27], v3 offset:58880
    s_mov_b64 exec, -1
    v_exp_f32 v50, v50
    v_exp_f32 v51, v51
    v_exp_f32 v52, v52
    v_mfma_f32_32x32x16_bf16 v[64:79], a[28:31], a[4:7], v[32:47]
    v_exp_f32 v53, v53
    v_exp_f32 v54, v54
    v_exp_f32 v55, v55
    v_exp_f32 v56, v56
    v_exp_f32 v57, v57
    v_smfmac_f32_32x32x32_bf16 v[80:95], a[32:35], v[48:55], v4
    v_exp_f32 v58, v58
    v_exp_f32 v59, v59
    v_exp_f32 v60, v60
    v_exp_f32 v61, v61
    v_exp_f32 v62, v62
    v_exp_f32 v63, v63
    v_exp_f32 v64, v64
    v_exp_f32 v65, v65
    v_smfmac_f32_32x32x32_bf16 v[80:95], a[36:39], v[56:63], v4
    v_exp_f32 v66, v66
    v_exp_f32 v67, v67
    v_exp_f32 v68, v68
    s_waitcnt lgkmcnt(0)
    v_mfma_f32_32x32x16_bf16 v[48:63], a[16:19], a[0:3], v[16:31]
    v_exp_f32 v69, v69
    v_exp_f32 v70, v70
    v_exp_f32 v71, v71
    v_exp_f32 v72, v72
    v_exp_f32 v73, v73
    v_smfmac_f32_32x32x32_bf16 v[96:111], a[32:35], v[64:71], v4
    v_exp_f32 v74, v74
    v_exp_f32 v75, v75
    v_exp_f32 v76, v76
    v_exp_f32 v77, v77
    v_exp_f32 v78, v78
    v_exp_f32 v79, v79
    v_exp_f32 v48, v48
    v_exp_f32 v49, v49
    v_smfmac_f32_32x32x32_bf16 v[96:111], a[36:39], v[72:79], v4
    ds_read_b128 a[28:31], v2 offset:59392
    s_mov_b64 exec, s[68:69]
    ds_read_b128 a[32:35], v3 offset:60416
    ds_read_b128 a[36:39], v3 offset:60928
    s_mov_b64 exec, -1
    v_exp_f32 v50, v50
    v_exp_f32 v51, v51
    v_exp_f32 v52, v52
    v_mfma_f32_32x32x16_bf16 v[64:79], a[16:19], a[4:7], v[32:47]
    v_exp_f32 v53, v53
    v_exp_f32 v54, v54
    v_exp_f32 v55, v55
    v_exp_f32 v56, v56
    v_exp_f32 v57, v57
    v_smfmac_f32_32x32x32_bf16 v[80:95], a[20:23], v[48:55], v4
    v_exp_f32 v58, v58
    v_exp_f32 v59, v59
    v_exp_f32 v60, v60
    v_exp_f32 v61, v61
    v_exp_f32 v62, v62
    v_exp_f32 v63, v63
    v_exp_f32 v64, v64
    v_exp_f32 v65, v65
    v_smfmac_f32_32x32x32_bf16 v[80:95], a[24:27], v[56:63], v4
    v_exp_f32 v66, v66
    v_exp_f32 v67, v67
    v_exp_f32 v68, v68
    s_waitcnt lgkmcnt(0)
    v_mfma_f32_32x32x16_bf16 v[48:63], a[28:31], a[0:3], v[16:31]
    v_exp_f32 v69, v69
    v_exp_f32 v70, v70
    v_exp_f32 v71, v71
    v_exp_f32 v72, v72
    v_exp_f32 v73, v73
    v_smfmac_f32_32x32x32_bf16 v[96:111], a[20:23], v[64:71], v4
    v_exp_f32 v74, v74
    v_exp_f32 v75, v75
    v_exp_f32 v76, v76
    v_exp_f32 v77, v77
    v_exp_f32 v78, v78
    v_exp_f32 v79, v79
    v_exp_f32 v48, v48
    v_exp_f32 v49, v49
    v_smfmac_f32_32x32x32_bf16 v[96:111], a[24:27], v[72:79], v4
    ds_read_b128 a[16:19], v2 offset:61440
    s_mov_b64 exec, s[68:69]
    ds_read_b128 a[20:23], v3 offset:62464
    ds_read_b128 a[24:27], v3 offset:62976
    s_mov_b64 exec, -1
    v_exp_f32 v50, v50
    v_exp_f32 v51, v51
    v_exp_f32 v52, v52
    v_mfma_f32_32x32x16_bf16 v[64:79], a[28:31], a[4:7], v[32:47]
    v_exp_f32 v53, v53
    v_exp_f32 v54, v54
    v_exp_f32 v55, v55
    v_exp_f32 v56, v56
    v_exp_f32 v57, v57
    v_smfmac_f32_32x32x32_bf16 v[80:95], a[32:35], v[48:55], v4
    v_exp_f32 v58, v58
    v_exp_f32 v59, v59
    v_exp_f32 v60, v60
    v_exp_f32 v61, v61
    v_exp_f32 v62, v62
    v_exp_f32 v63, v63
    v_exp_f32 v64, v64
    v_exp_f32 v65, v65
    v_smfmac_f32_32x32x32_bf16 v[80:95], a[36:39], v[56:63], v4
    v_exp_f32 v66, v66
    v_exp_f32 v67, v67
    v_exp_f32 v68, v68
    s_waitcnt lgkmcnt(0)
    v_mfma_f32_32x32x16_bf16 v[48:63], a[16:19], a[0:3], v[16:31]
    v_exp_f32 v69, v69
    v_exp_f32 v70, v70
    v_exp_f32 v71, v71
    v_exp_f32 v72, v72
    v_exp_f32 v73, v73
    v_smfmac_f32_32x32x32_bf16 v[96:111], a[32:35], v[64:71], v4
    v_exp_f32 v74, v74
    v_exp_f32 v75, v75
    v_exp_f32 v76, v76
    v_exp_f32 v77, v77
    v_exp_f32 v78, v78
    v_exp_f32 v79, v79
    v_exp_f32 v48, v48
    v_exp_f32 v49, v49
    v_smfmac_f32_32x32x32_bf16 v[96:111], a[36:39], v[72:79], v4
    s_cmp_eq_u32 s59, 1
    s_cbranch_scc1 L_hookx
L_back30:
    ds_read_b128 a[28:31], v2 offset:63488
    s_mov_b64 exec, s[68:69]
    ds_read_b128 a[32:35], v3 offset:64512
    ds_read_b128 a[36:39], v3 offset:65024
    s_mov_b64 exec, -1
    v_exp_f32 v50, v50
    v_exp_f32 v51, v51
    v_exp_f32 v52, v52
    v_mfma_f32_32x32x16_bf16 v[64:79], a[16:19], a[4:7], v[32:47]
    v_exp_f32 v53, v53
    v_exp_f32 v54, v54
    v_exp_f32 v55, v55
    v_exp_f32 v56, v56
    v_exp_f32 v57, v57
    v_smfmac_f32_32x32x32_bf16 v[80:95], a[20:23], v[48:55], v4
    v_exp_f32 v58, v58
    v_exp_f32 v59, v59
    v_exp_f32 v60, v60
    v_exp_f32 v61, v61
    v_exp_f32 v62, v62
    v_exp_f32 v63, v63
    v_exp_f32 v64, v64
    v_exp_f32 v65, v65
    v_smfmac_f32_32x32x32_bf16 v[80:95], a[24:27], v[56:63], v4
    v_exp_f32 v66, v66
    v_exp_f32 v67, v67
    v_exp_f32 v68, v68
    s_waitcnt lgkmcnt(0)
    v_mfma_f32_32x32x16_bf16 v[48:63], a[28:31], a[0:3], v[16:31]
    v_exp_f32 v69, v69
    v_exp_f32 v70, v70
    v_exp_f32 v71, v71
    v_exp_f32 v72, v72
    v_exp_f32 v73, v73
    v_smfmac_f32_32x32x32_bf16 v[96:111], a[20:23], v[64:71], v4
    v_exp_f32 v74, v74
    v_exp_f32 v75, v75
    v_exp_f32 v76, v76
    v_exp_f32 v77, v77
    v_exp_f32 v78, v78
    v_exp_f32 v79, v79
    v_exp_f32 v48, v48
    v_exp_f32 v49, v49
    v_smfmac_f32_32x32x32_bf16 v[96:111], a[24:27], v[72:79], v4
    v_exp_f32 v50, v50
    v_exp_f32 v51, v51
    v_exp_f32 v52, v52
    v_mfma_f32_32x32x16_bf16 v[64:79], a[28:31], a[4:7], v[32:47]
    v_exp_f32 v53, v53
    v_exp_f32 v54, v54
    v_exp_f32 v55, v55
    v_exp_f32 v56, v56
    v_exp_f32 v57, v57
    v_smfmac_f32_32x32x32_bf16 v[80:95], a[32:35], v[48:55], v4
    v_exp_f32 v58, v58
    v_exp_f32 v59, v59
    v_exp_f32 v60, v60
    v_exp_f32 v61, v61
    v_exp_f32 v62, v62
    v_exp_f32 v63, v63
    v_exp_f32 v64, v64
    v_exp_f32 v65, v65
    v_smfmac_f32_32x32x32_bf16 v[80:95], a[36:39], v[56:63], v4
    v_exp_f32 v66, v66
    v_exp_f32 v67, v67
    v_exp_f32 v68, v68
    v_exp_f32 v69, v69
    v_exp_f32 v70, v70
    v_exp_f32 v71, v71
    v_exp_f32 v72, v72
    v_exp_f32 v73, v73
    v_smfmac_f32_32x32x32_bf16 v[96:111], a[32:35], v[64:71], v4
    v_exp_f32 v74, v74
    v_exp_f32 v75, v75
    v_exp_f32 v76, v76
    v_exp_f32 v77, v77
    v_exp_f32 v78, v78
    v_exp_f32 v79, v79
    s_mov_b32 s60, 0x71800000
    s_nop 0
    v_smfmac_f32_32x32x32_bf16 v[96:111], a[36:39], v[72:79], v4
    v_maximum3_f32 v12, abs(v80), abs(v81), abs(v82)
    v_maximum3_f32 v6, abs(v83), abs(v84), abs(v85)
    v_maximum3_f32 v12, v12, abs(v86), abs(v87)
    v_maximum3_f32 v12, v12, v6, v6
    v_mov_b32 v6, v12
    s_mov_b32 s61, 0xb800000
    s_nop 0
    v_permlane32_swap_b32 v6, v12
    s_nop 0
    v_maximum3_f32 v12, v12, v6, v6
    v_maximum3_f32 v14, v12, v88, v88
    s_nop 0
    v_maximum3_f32 v13, abs(v96), abs(v97), abs(v98)
    v_maximum3_f32 v8, abs(v99), abs(v100), abs(v101)
    v_maximum3_f32 v13, v13, abs(v102), abs(v103)
    v_maximum3_f32 v13, v13, v8, v8
    v_mov_b32 v8, v13
    v_maximum3_f32 v14, v14, v104, v104
    s_nop 0
    v_permlane32_swap_b32 v8, v13
    s_nop 0
    v_maximum3_f32 v14, v14, v13, v8
    v_maximum3_f32 v13, v13, v8, v8
    v_cmp_nle_f32 vcc, v14, s60
    v_minimum3_f32 v12, v12, v13, v13
    v_cmp_nge_f32 s[70:71], v12, s61
    s_nop 0
    s_or_b64 vcc, vcc, s[70:71]
    s_cbranch_vccnz L_fallback
L_fin:
    v_mov_b32 v89, v16
    v_mov_b32 v105, v32
    s_waitcnt vmcnt(0) lgkmcnt(0)
    s_cmp_eq_u32 s59, 0
    s_cbranch_scc0 L_fin_a
    v_accvgpr_mov_b32 a0, a8
    v_accvgpr_mov_b32 a1, a9
    v_accvgpr_mov_b32 a2, a10
    v_accvgpr_mov_b32 a3, a11
    v_accvgpr_mov_b32 a4, a12
    v_accvgpr_mov_b32 a5, a13
    v_accvgpr_mov_b32 a6, a14
    v_accvgpr_mov_b32 a7, a15
    v_add_u32 v2, s33, v1
    v_add_u32 v3, s33, v196
    s_mov_b32 s59, 1
    s_cmp_eq_u32 s76, 0
    s_cbranch_scc0 L_fin_b1
    s_mov_b32 s7, 1
    v_pk_mov_b32 v[144:145], v[80:81], v[80:81] op_sel:[0,1]
    v_pk_mov_b32 v[146:147], v[82:83], v[82:83] op_sel:[0,1]
    v_pk_mov_b32 v[148:149], v[84:85], v[84:85] op_sel:[0,1]
    v_pk_mov_b32 v[150:151], v[86:87], v[86:87] op_sel:[0,1]
    v_pk_mov_b32 v[152:153], v[88:89], v[88:89] op_sel:[0,1]
    v_pk_mov_b32 v[154:155], v[96:97], v[96:97] op_sel:[0,1]
    v_pk_mov_b32 v[156:157], v[98:99], v[98:99] op_sel:[0,1]
    v_pk_mov_b32 v[158:159], v[100:101], v[100:101] op_sel:[0,1]
    v_pk_mov_b32 v[160:161], v[102:103], v[102:103] op_sel:[0,1]
    v_pk_mov_b32 v[162:163], v[104:105], v[104:105] op_sel:[0,1]
    s_branch L_max
L_fin_b1:
    s_barrier
    ds_read_b128 a[16:19], v2
    s_mov_b64 exec, s[68:69]
    ds_read_b128 a[20:23], v3 offset:1024
    ds_read_b128 a[24:27], v3 offset:1536
    s_mov_b64 exec, -1
    v_pk_mov_b32 v[144:145], v[96:97], v[96:97] op_sel:[0,1]
    v_pk_mov_b32 v[146:147], v[98:99], v[98:99] op_sel:[0,1]
    v_pk_mov_b32 v[148:149], v[100:101], v[100:101] op_sel:[0,1]
    v_pk_mov_b32 v[150:151], v[102:103], v[102:103] op_sel:[0,1]
    v_pk_mov_b32 v[152:153], v[104:105], v[104:105] op_sel:[0,1]
    v_pk_mov_b32 v[154:155], v[80:81], v[80:81] op_sel:[0,1]
    v_pk_mov_b32 v[156:157], v[82:83], v[82:83] op_sel:[0,1]
    v_pk_mov_b32 v[158:159], v[84:85], v[84:85] op_sel:[0,1]
    v_pk_mov_b32 v[160:161], v[86:87], v[86:87] op_sel:[0,1]
    v_pk_mov_b32 v[162:163], v[88:89], v[88:89] op_sel:[0,1]
    s_branch L_max
L_fin_a:
    s_cmp_eq_u32 s76, 0
    s_cbranch_scc0 L_fin_a1
    s_barrier
    ds_write_b128 v184, v[80:83] offset:0
    ds_write_b128 v184, v[84:87] offset:1024
    ds_write_b64 v185, v[88:89] offset:2048
    ds_write_b128 v184, v[96:99] offset:2560
    ds_write_b128 v184, v[100:103] offset:3584
    ds_write_b64 v185, v[104:105] offset:4608
    s_setprio 0
    s_waitcnt lgkmcnt(0)
    s_barrier
    s_branch L_bhalf
L_fin_a1:
    s_add_u32 s60, s36, 65536
    s_barrier
    ds_read_b64 v[56:57], v185 offset:2048
    ds_read_b128 v[48:51], v184 offset:0
    ds_read_b128 v[52:55], v184 offset:1024
    ds_read_b64 v[72:73], v185 offset:4608
    ds_read_b128 v[64:67], v184 offset:2560
    ds_read_b128 v[68:71], v184 offset:3584
    s_waitcnt lgkmcnt(5)
    v_min_f32 v12, v89, v57
    v_sub_f32 v13, v12, v89
    v_sub_f32 v14, v12, v57
    v_max_f32 v13, 0xc3960000, v13
    v_max_f32 v14, 0xc3960000, v14
    v_cvt_i32_f32 v13, v13
    v_cvt_i32_f32 v14, v14
    s_waitcnt lgkmcnt(2)
    v_ldexp_f32 v88, v88, v13
    v_min_f32 v6, v105, v73
    v_ldexp_f32 v56, v56, v14
    v_sub_f32 v8, v6, v105
    v_add_f32 v12, v88, v56
    v_sub_f32 v9, v6, v73
    v_rcp_f32 v12, v12
    v_max_f32 v8, 0xc3960000, v8
    s_nop 0
    v_max_f32 v9, 0xc3960000, v9
    v_ldexp_f32 v13, v12, v13
    v_cvt_i32_f32 v8, v8
    v_ldexp_f32 v14, v12, v14
    v_cvt_i32_f32 v9, v9
    v_ldexp_f32 v104, v104, v8
    v_ldexp_f32 v72, v72, v9
    v_add_f32 v6, v104, v72
    v_rcp_f32 v6, v6
    s_nop 0
    v_ldexp_f32 v8, v6, v8
    v_ldexp_f32 v9, v6, v9
    s_waitcnt lgkmcnt(0)
    v_pk_mul_f32 v[80:81], v[80:81], v[12:13] op_sel:[0,1] op_sel_hi:[1,1]
    v_pk_mul_f32 v[82:83], v[82:83], v[12:13] op_sel:[0,1] op_sel_hi:[1,1]
    v_pk_mul_f32 v[84:85], v[84:85], v[12:13] op_sel:[0,1] op_sel_hi:[1,1]
    v_pk_mul_f32 v[86:87], v[86:87], v[12:13] op_sel:[0,1] op_sel_hi:[1,1]
    v_pk_fma_f32 v[80:81], v[48:49], v[14:15], v[80:81] op_sel:[0,0,0] op_sel_hi:[1,0,1]
    v_pk_fma_f32 v[82:83], v[50:51], v[14:15], v[82:83] op_sel:[0,0,0] op_sel_hi:[1,0,1]
    v_pk_fma_f32 v[84:85], v[52:53], v[14:15], v[84:85] op_sel:[0,0,0] op_sel_hi:[1,0,1]
    v_pk_fma_f32 v[86:87], v[54:55], v[14:15], v[86:87] op_sel:[0,0,0] op_sel_hi:[1,0,1]
    v_cvt_pk_bf16_f32 v80, v80, v81
    v_cvt_pk_bf16_f32 v81, v82, v83
    v_cvt_pk_bf16_f32 v82, v84, v85
    v_cvt_pk_bf16_f32 v83, v86, v87
    buffer_store_dwordx4 v[80:83], v1, s[28:31], s36 offen sc1
    v_pk_mul_f32 v[96:97], v[96:97], v[8:9] op_sel:[0,0] op_sel_hi:[1,0]
    v_pk_mul_f32 v[98:99], v[98:99], v[8:9] op_sel:[0,0] op_sel_hi:[1,0]
    v_pk_mul_f32 v[100:101], v[100:101], v[8:9] op_sel:[0,0] op_sel_hi:[1,0]
    v_pk_mul_f32 v[102:103], v[102:103], v[8:9] op_sel:[0,0] op_sel_hi:[1,0]
    v_pk_fma_f32 v[96:97], v[64:65], v[8:9], v[96:97] op_sel:[0,1,0] op_sel_hi:[1,1,1]
    v_pk_fma_f32 v[98:99], v[66:67], v[8:9], v[98:99] op_sel:[0,1,0] op_sel_hi:[1,1,1]
    v_pk_fma_f32 v[100:101], v[68:69], v[8:9], v[100:101] op_sel:[0,1,0] op_sel_hi:[1,1,1]
    v_pk_fma_f32 v[102:103], v[70:71], v[8:9], v[102:103] op_sel:[0,1,0] op_sel_hi:[1,1,1]
    v_cvt_pk_bf16_f32 v96, v96, v97
    v_cvt_pk_bf16_f32 v97, v98, v99
    v_cvt_pk_bf16_f32 v98, v100, v101
    v_cvt_pk_bf16_f32 v99, v102, v103
    buffer_store_dwordx4 v[96:99], v1, s[28:31], s60 offen sc1
L_bhalf:
    ds_read_b64_tr_b16 v[16:17], v182 offset:0
    ds_read_b64_tr_b16 v[18:19], v182 offset:1024
    ds_read_b64_tr_b16 v[20:21], v183 offset:0
    ds_read_b64_tr_b16 v[22:23], v183 offset:1024
    ds_read_b64_tr_b16 v[24:25], v182 offset:2048
    ds_read_b64_tr_b16 v[26:27], v182 offset:3072
    ds_read_b64_tr_b16 v[28:29], v183 offset:2048
    ds_read_b64_tr_b16 v[30:31], v183 offset:3072
    ds_read_b64_tr_b16 v[32:33], v182 offset:4096
    ds_read_b64_tr_b16 v[34:35], v182 offset:5120
    ds_read_b64_tr_b16 v[36:37], v183 offset:4096
    ds_read_b64_tr_b16 v[38:39], v183 offset:5120
    s_waitcnt lgkmcnt(8)
    v_mfma_f32_32x32x16_bf16 v[144:159], v[16:19], v[112:115], 0
    v_mfma_f32_32x32x16_bf16 v[160:175], v[20:23], v[112:115], 0
    ds_read_b64_tr_b16 v[40:41], v182 offset:6144
    ds_read_b64_tr_b16 v[42:43], v182 offset:7168
    ds_read_b64_tr_b16 v[44:45], v183 offset:6144
    ds_read_b64_tr_b16 v[46:47], v183 offset:7168
    s_waitcnt lgkmcnt(8)
    v_mfma_f32_32x32x16_bf16 v[144:159], v[24:27], v[116:119], v[144:159]
    v_mfma_f32_32x32x16_bf16 v[160:175], v[28:31], v[116:119], v[160:175]
    ds_read_b64_tr_b16 v[48:49], v182 offset:8192
    ds_read_b64_tr_b16 v[50:51], v182 offset:9216
    ds_read_b64_tr_b16 v[52:53], v183 offset:8192
    ds_read_b64_tr_b16 v[54:55], v183 offset:9216
    s_waitcnt lgkmcnt(8)
    v_mfma_f32_32x32x16_bf16 v[144:159], v[32:35], v[120:123], v[144:159]
    v_mfma_f32_32x32x16_bf16 v[160:175], v[36:39], v[120:123], v[160:175]
    ds_read_b64_tr_b16 v[56:57], v182 offset:10240
    ds_read_b64_tr_b16 v[58:59], v182 offset:11264
    ds_read_b64_tr_b16 v[60:61], v183 offset:10240
    ds_read_b64_tr_b16 v[62:63], v183 offset:11264
    s_waitcnt lgkmcnt(8)
    v_mfma_f32_32x32x16_bf16 v[144:159], v[40:43], v[124:127], v[144:159]
    v_mfma_f32_32x32x16_bf16 v[160:175], v[44:47], v[124:127], v[160:175]
    ds_read_b64_tr_b16 v[64:65], v182 offset:12288
    ds_read_b64_tr_b16 v[66:67], v182 offset:13312
    ds_read_b64_tr_b16 v[68:69], v183 offset:12288
    ds_read_b64_tr_b16 v[70:71], v183 offset:13312
    s_waitcnt lgkmcnt(8)
    v_mfma_f32_32x32x16_bf16 v[144:159], v[48:51], v[128:131], v[144:159]
    v_mfma_f32_32x32x16_bf16 v[160:175], v[52:55], v[128:131], v[160:175]
    ds_read_b64_tr_b16 v[72:73], v182 offset:14336
    ds_read_b64_tr_b16 v[74:75], v182 offset:15360
    ds_read_b64_tr_b16 v[76:77], v183 offset:14336
    ds_read_b64_tr_b16 v[78:79], v183 offset:15360
    s_waitcnt lgkmcnt(8)
    v_mfma_f32_32x32x16_bf16 v[144:159], v[56:59], v[132:135], v[144:159]
    v_mfma_f32_32x32x16_bf16 v[160:175], v[60:63], v[132:135], v[160:175]
    s_waitcnt lgkmcnt(4)
    v_mfma_f32_32x32x16_bf16 v[144:159], v[64:67], v[136:139], v[144:159]
    v_mfma_f32_32x32x16_bf16 v[160:175], v[68:71], v[136:139], v[160:175]
    s_waitcnt lgkmcnt(0)
    v_mfma_f32_32x32x16_bf16 v[144:159], v[72:75], v[140:143], v[144:159]
    v_mfma_f32_32x32x16_bf16 v[160:175], v[76:79], v[140:143], v[160:175]
    v_sub_f32 v11, 1.0, v5
    s_nop 11
    v_pk_mul_f32 v[144:145], v[144:145], v[10:11] op_sel:[0,1] op_sel_hi:[1,1]
    v_pk_mul_f32 v[146:147], v[146:147], v[10:11] op_sel:[0,1] op_sel_hi:[1,1]
    v_pk_mul_f32 v[148:149], v[148:149], v[10:11] op_sel:[0,1] op_sel_hi:[1,1]
    v_pk_mul_f32 v[150:151], v[150:151], v[10:11] op_sel:[0,1] op_sel_hi:[1,1]
    v_pk_mul_f32 v[152:153], v[152:153], v[10:11] op_sel:[0,1] op_sel_hi:[1,1]
    v_pk_mul_f32 v[154:155], v[154:155], v[10:11] op_sel:[0,1] op_sel_hi:[1,1]
    v_pk_mul_f32 v[156:157], v[156:157], v[10:11] op_sel:[0,1] op_sel_hi:[1,1]
    v_pk_mul_f32 v[158:159], v[158:159], v[10:11] op_sel:[0,1] op_sel_hi:[1,1]
    v_pk_mul_f32 v[160:161], v[160:161], v[10:11] op_sel:[0,1] op_sel_hi:[1,1]
    v_pk_mul_f32 v[162:163], v[162:163], v[10:11] op_sel:[0,1] op_sel_hi:[1,1]
    v_pk_mul_f32 v[164:165], v[164:165], v[10:11] op_sel:[0,1] op_sel_hi:[1,1]
    v_pk_mul_f32 v[166:167], v[166:167], v[10:11] op_sel:[0,1] op_sel_hi:[1,1]
    v_pk_mul_f32 v[168:169], v[168:169], v[10:11] op_sel:[0,1] op_sel_hi:[1,1]
    v_pk_mul_f32 v[170:171], v[170:171], v[10:11] op_sel:[0,1] op_sel_hi:[1,1]
    v_pk_mul_f32 v[172:173], v[172:173], v[10:11] op_sel:[0,1] op_sel_hi:[1,1]
    v_pk_mul_f32 v[174:175], v[174:175], v[10:11] op_sel:[0,1] op_sel_hi:[1,1]
L_bdone:
    ds_read_b64_tr_b16 v[16:17], v180 offset:0
    ds_read_b64_tr_b16 v[18:19], v180 offset:1024
    ds_read_b64_tr_b16 v[20:21], v181 offset:0
    ds_read_b64_tr_b16 v[22:23], v181 offset:1024
    ds_read_b64_tr_b16 v[24:25], v180 offset:2048
    ds_read_b64_tr_b16 v[26:27], v180 offset:3072
    ds_read_b64_tr_b16 v[28:29], v181 offset:2048
    ds_read_b64_tr_b16 v[30:31], v181 offset:3072
    ds_read_b64_tr_b16 v[32:33], v180 offset:4096
    ds_read_b64_tr_b16 v[34:35], v180 offset:5120
    ds_read_b64_tr_b16 v[36:37], v181 offset:4096
    ds_read_b64_tr_b16 v[38:39], v181 offset:5120
    s_waitcnt lgkmcnt(8)
    ds_read_b64_tr_b16 v[40:41], v180 offset:6144
    ds_read_b64_tr_b16 v[42:43], v180 offset:7168
    ds_read_b64_tr_b16 v[44:45], v181 offset:6144
    ds_read_b64_tr_b16 v[46:47], v181 offset:7168
    s_waitcnt lgkmcnt(8)
    ds_read_b64_tr_b16 v[48:49], v180 offset:8192
    ds_read_b64_tr_b16 v[50:51], v180 offset:9216
    ds_read_b64_tr_b16 v[52:53], v181 offset:8192
    ds_read_b64_tr_b16 v[54:55], v181 offset:9216
    s_waitcnt lgkmcnt(8)
    ds_read_b64_tr_b16 v[56:57], v180 offset:10240
    ds_read_b64_tr_b16 v[58:59], v180 offset:11264
    ds_read_b64_tr_b16 v[60:61], v181 offset:10240
    ds_read_b64_tr_b16 v[62:63], v181 offset:11264
    s_waitcnt lgkmcnt(8)
    ds_read_b64_tr_b16 v[64:65], v180 offset:12288
    ds_read_b64_tr_b16 v[66:67], v180 offset:13312
    ds_read_b64_tr_b16 v[68:69], v181 offset:12288
    ds_read_b64_tr_b16 v[70:71], v181 offset:13312
    s_waitcnt lgkmcnt(8)
    ds_read_b64_tr_b16 v[72:73], v180 offset:14336
    ds_read_b64_tr_b16 v[74:75], v180 offset:15360
    ds_read_b64_tr_b16 v[76:77], v181 offset:14336
    ds_read_b64_tr_b16 v[78:79], v181 offset:15360
    s_barrier
    s_mov_b32 s65, 100000
    v_and_b32 v6, 7, v0
    v_lshlrev_b32 v6, 10, v6
    v_add_u32 v6, 1020, v6
    buffer_load_dword v10, v6, s[28:31], s4 offen sc1
    s_waitcnt vmcnt(0)
    v_cmp_eq_u32 vcc, -1, v10
    s_cbranch_vccz L_ok_20
    v_and_b32 v6, 7, v0
    v_lshlrev_b32 v6, 10, v6
    v_add_u32 v6, 1020, v6
    s_mov_b32 s78, 300000
L_spin_19:
    buffer_load_dword v10, v6, s[28:31], s4 offen sc1
    s_waitcnt vmcnt(0)
    v_cmp_eq_u32 vcc, -1, v10
    s_cbranch_vccz L_ok_20
    s_sub_u32 s78, s78, 1
    s_cmp_lg_u32 s78, 0
    s_cbranch_scc1 L_spin_19
L_ok_20:
L_oagain:
    s_add_u32 s62, s4, 0
    buffer_load_dwordx4 v[112:115], v1, s[28:31], s62 offen offset:0 sc1
    buffer_load_dwordx4 v[116:119], v1, s[28:31], s62 offen offset:1024 sc1
    buffer_load_dwordx4 v[120:123], v1, s[28:31], s62 offen offset:2048 sc1
    buffer_load_dwordx4 v[124:127], v1, s[28:31], s62 offen offset:3072 sc1
    s_add_u32 s62, s62, 4096
    buffer_load_dwordx4 v[128:131], v1, s[28:31], s62 offen offset:0 sc1
    buffer_load_dwordx4 v[132:135], v1, s[28:31], s62 offen offset:1024 sc1
    buffer_load_dwordx4 v[136:139], v1, s[28:31], s62 offen offset:2048 sc1
    buffer_load_dwordx4 v[140:143], v1, s[28:31], s62 offen offset:3072 sc1
    s_waitcnt lgkmcnt(0)
    s_waitcnt vmcnt(7)
    v_mfma_f32_32x32x16_bf16 v[80:95], v[16:19], v[112:115], 0
    v_mfma_f32_32x32x16_bf16 v[96:111], v[20:23], v[112:115], 0
    v_max3_u32 v10, v112, v113, v114
    v_max_u32 v10, v10, v115
    s_waitcnt vmcnt(6)
    v_mfma_f32_32x32x16_bf16 v[80:95], v[24:27], v[116:119], v[80:95]
    v_mfma_f32_32x32x16_bf16 v[96:111], v[28:31], v[116:119], v[96:111]
    v_max3_u32 v10, v10, v116, v117
    v_max3_u32 v10, v10, v118, v119
    s_waitcnt vmcnt(5)
    v_mfma_f32_32x32x16_bf16 v[80:95], v[32:35], v[120:123], v[80:95]
    v_mfma_f32_32x32x16_bf16 v[96:111], v[36:39], v[120:123], v[96:111]
    v_max3_u32 v10, v10, v120, v121
    v_max3_u32 v10, v10, v122, v123
    s_waitcnt vmcnt(4)
    v_mfma_f32_32x32x16_bf16 v[80:95], v[40:43], v[124:127], v[80:95]
    v_mfma_f32_32x32x16_bf16 v[96:111], v[44:47], v[124:127], v[96:111]
    v_max3_u32 v10, v10, v124, v125
    v_max3_u32 v10, v10, v126, v127
    s_waitcnt vmcnt(3)
    v_mfma_f32_32x32x16_bf16 v[80:95], v[48:51], v[128:131], v[80:95]
    v_mfma_f32_32x32x16_bf16 v[96:111], v[52:55], v[128:131], v[96:111]
    v_max3_u32 v10, v10, v128, v129
    v_max3_u32 v10, v10, v130, v131
    s_waitcnt vmcnt(2)
    v_mfma_f32_32x32x16_bf16 v[80:95], v[56:59], v[132:135], v[80:95]
    v_mfma_f32_32x32x16_bf16 v[96:111], v[60:63], v[132:135], v[96:111]
    v_max3_u32 v10, v10, v132, v133
    v_max3_u32 v10, v10, v134, v135
    s_waitcnt vmcnt(1)
    v_mfma_f32_32x32x16_bf16 v[80:95], v[64:67], v[136:139], v[80:95]
    v_mfma_f32_32x32x16_bf16 v[96:111], v[68:71], v[136:139], v[96:111]
    v_max3_u32 v10, v10, v136, v137
    v_max3_u32 v10, v10, v138, v139
    s_waitcnt vmcnt(0)
    v_mfma_f32_32x32x16_bf16 v[80:95], v[72:75], v[140:143], v[80:95]
    v_mfma_f32_32x32x16_bf16 v[96:111], v[76:79], v[140:143], v[96:111]
    v_max3_u32 v10, v10, v140, v141
    v_max3_u32 v10, v10, v142, v143
    v_cmp_eq_u32 vcc, -1, v10
    s_sub_u32 s65, s65, 1
    s_cbranch_vccz L_ook
    s_cmp_lg_u32 s65, 0
    s_cbranch_scc1 L_oagain
L_ook:
    s_nop 8
    v_pk_fma_f32 v[152:153], v[88:89], v[4:5], v[152:153] op_sel:[0,1,0] op_sel_hi:[1,1,1]
    v_pk_fma_f32 v[154:155], v[90:91], v[4:5], v[154:155] op_sel:[0,1,0] op_sel_hi:[1,1,1]
    v_pk_fma_f32 v[156:157], v[92:93], v[4:5], v[156:157] op_sel:[0,1,0] op_sel_hi:[1,1,1]
    v_pk_fma_f32 v[158:159], v[94:95], v[4:5], v[158:159] op_sel:[0,1,0] op_sel_hi:[1,1,1]
    ds_write_b128 v186, v[152:155]
    ds_write_b128 v186, v[156:159] offset:1024
    v_pk_fma_f32 v[160:161], v[96:97], v[4:5], v[160:161] op_sel:[0,1,0] op_sel_hi:[1,1,1]
    v_pk_fma_f32 v[162:163], v[98:99], v[4:5], v[162:163] op_sel:[0,1,0] op_sel_hi:[1,1,1]
    v_pk_fma_f32 v[164:165], v[100:101], v[4:5], v[164:165] op_sel:[0,1,0] op_sel_hi:[1,1,1]
    v_pk_fma_f32 v[166:167], v[102:103], v[4:5], v[166:167] op_sel:[0,1,0] op_sel_hi:[1,1,1]
    ds_write_b128 v187, v[160:163]
    ds_write_b128 v187, v[164:167] offset:1024
    v_pk_fma_f32 v[168:169], v[104:105], v[4:5], v[168:169] op_sel:[0,1,0] op_sel_hi:[1,1,1]
    v_pk_fma_f32 v[170:171], v[106:107], v[4:5], v[170:171] op_sel:[0,1,0] op_sel_hi:[1,1,1]
    v_pk_fma_f32 v[172:173], v[108:109], v[4:5], v[172:173] op_sel:[0,1,0] op_sel_hi:[1,1,1]
    v_pk_fma_f32 v[174:175], v[110:111], v[4:5], v[174:175] op_sel:[0,1,0] op_sel_hi:[1,1,1]
    ds_write_b128 v188, v[168:171]
    ds_write_b128 v188, v[172:175] offset:1024
    v_pk_fma_f32 v[144:145], v[80:81], v[4:5], v[144:145] op_sel:[0,1,0] op_sel_hi:[1,1,1]
    v_pk_fma_f32 v[146:147], v[82:83], v[4:5], v[146:147] op_sel:[0,1,0] op_sel_hi:[1,1,1]
    v_pk_fma_f32 v[148:149], v[84:85], v[4:5], v[148:149] op_sel:[0,1,0] op_sel_hi:[1,1,1]
    v_pk_fma_f32 v[150:151], v[86:87], v[4:5], v[150:151] op_sel:[0,1,0] op_sel_hi:[1,1,1]
    s_waitcnt lgkmcnt(0)
    s_barrier
    ds_read_b128 v[112:115], v190
    ds_read_b128 v[116:119], v190 offset:1024
    ds_read_b128 v[120:123], v190 offset:16384
    ds_read_b128 v[124:127], v190 offset:17408
    ds_read_b128 v[128:131], v189 offset:49152
    ds_read_b128 v[132:135], v189 offset:50176
    s_waitcnt lgkmcnt(4)
    v_pk_add_f32 v[144:145], v[144:145], v[112:113]
    v_pk_add_f32 v[146:147], v[146:147], v[114:115]
    v_pk_add_f32 v[148:149], v[148:149], v[116:117]
    v_pk_add_f32 v[150:151], v[150:151], v[118:119]
    s_waitcnt lgkmcnt(0)
    v_pk_add_f32 v[120:121], v[120:121], v[128:129]
    v_pk_add_f32 v[122:123], v[122:123], v[130:131]
    v_pk_add_f32 v[124:125], v[124:125], v[132:133]
    v_pk_add_f32 v[126:127], v[126:127], v[134:135]
    v_pk_add_f32 v[144:145], v[144:145], v[120:121]
    v_pk_add_f32 v[146:147], v[146:147], v[122:123]
    v_pk_add_f32 v[148:149], v[148:149], v[124:125]
    v_pk_add_f32 v[150:151], v[150:151], v[126:127]
    v_cvt_pk_bf16_f32 v144, v144, v145
    v_cvt_pk_bf16_f32 v145, v146, v147
    v_cvt_pk_bf16_f32 v146, v148, v149
    v_cvt_pk_bf16_f32 v147, v150, v151
    buffer_store_dwordx4 v[144:147], v191, s[8:11], s74 offen
    s_or_b32 s60, s2, s52
    s_cmp_lg_u32 s60, 0
    s_cbranch_scc1 L_end
    s_mov_b32 s60, 13631488
    v_mov_b32 v6, 0
    v_mov_b32 v7, s55
    s_mov_b64 exec, 1
    buffer_store_dword v7, v6, s[28:31], s60 offen sc1
    s_mov_b64 exec, -1
L_end:
    s_endpgm
L_hookd:
    s_cmp_ge_u32 s52, 4
    s_cbranch_scc1 L_back5
    s_lshl_b32 s60, s53, 7
    s_lshl_b32 s61, s54, 2
    s_add_u32 s60, s60, s61
    s_add_u32 s60, s60, s52
    s_lshl_b32 s60, s60, 10
    s_add_u32 s60, s60, 9437184
    s_add_u32 s61, s60, 65536
    v_mov_b32 v12, -1
    v_mov_b32 v13, -1
    v_mov_b32 v14, -1
    v_mov_b32 v15, -1
    buffer_store_dwordx4 v[12:15], v1, s[28:31], s60 offen sc1
    buffer_store_dwordx4 v[12:15], v1, s[28:31], s61 offen sc1
    s_cmp_ge_u32 s52, 2
    s_cbranch_scc1 L_def1
    s_add_u32 s63, s6, 65536
    v_pk_mul_f32 v[128:129], v[128:129], s[66:67] op_sel:[0,1] op_sel_hi:[1,1]
    v_pk_mul_f32 v[130:131], v[130:131], s[66:67] op_sel:[0,1] op_sel_hi:[1,1]
    v_pk_mul_f32 v[132:133], v[132:133], s[66:67] op_sel:[0,1] op_sel_hi:[1,1]
    v_pk_mul_f32 v[134:135], v[134:135], s[66:67] op_sel:[0,1] op_sel_hi:[1,1]
    v_pk_mul_f32 v[136:137], v[136:137], s[66:67] op_sel:[0,1] op_sel_hi:[1,1]
    v_pk_mul_f32 v[138:139], v[138:139], s[66:67] op_sel:[0,1] op_sel_hi:[1,1]
    v_pk_mul_f32 v[140:141], v[140:141], s[66:67] op_sel:[0,1] op_sel_hi:[1,1]
    v_pk_mul_f32 v[142:143], v[142:143], s[66:67] op_sel:[0,1] op_sel_hi:[1,1]
    v_cvt_pk_bf16_f32 v128, v128, v129
    v_cvt_pk_bf16_f32 v129, v130, v131
    v_cvt_pk_bf16_f32 v130, v132, v133
    v_cvt_pk_bf16_f32 v131, v134, v135
    v_cvt_pk_bf16_f32 v132, v136, v137
    v_cvt_pk_bf16_f32 v133, v138, v139
    v_cvt_pk_bf16_f32 v134, v140, v141
    v_cvt_pk_bf16_f32 v135, v142, v143
    buffer_store_dwordx4 v[128:131], v1, s[28:31], s6 offen offset:0 sc1
    buffer_store_dwordx4 v[132:135], v1, s[28:31], s63 offen offset:0 sc1
    v_pk_mul_f32 v[160:161], v[160:161], s[66:67] op_sel:[0,1] op_sel_hi:[1,1]
    v_pk_mul_f32 v[162:163], v[162:163], s[66:67] op_sel:[0,1] op_sel_hi:[1,1]
    v_pk_mul_f32 v[164:165], v[164:165], s[66:67] op_sel:[0,1] op_sel_hi:[1,1]
    v_pk_mul_f32 v[166:167], v[166:167], s[66:67] op_sel:[0,1] op_sel_hi:[1,1]
    v_pk_mul_f32 v[168:169], v[168:169], s[66:67] op_sel:[0,1] op_sel_hi:[1,1]
    v_pk_mul_f32 v[170:171], v[170:171], s[66:67] op_sel:[0,1] op_sel_hi:[1,1]
    v_pk_mul_f32 v[172:173], v[172:173], s[66:67] op_sel:[0,1] op_sel_hi:[1,1]
    v_pk_mul_f32 v[174:175], v[174:175], s[66:67] op_sel:[0,1] op_sel_hi:[1,1]
    v_cvt_pk_bf16_f32 v160, v160, v161
    v_cvt_pk_bf16_f32 v161, v162, v163
    v_cvt_pk_bf16_f32 v162, v164, v165
    v_cvt_pk_bf16_f32 v163, v166, v167
    v_cvt_pk_bf16_f32 v164, v168, v169
    v_cvt_pk_bf16_f32 v165, v170, v171
    v_cvt_pk_bf16_f32 v166, v172, v173
    v_cvt_pk_bf16_f32 v167, v174, v175
    buffer_store_dwordx4 v[160:163], v1, s[28:31], s6 offen offset:1024 sc1
    buffer_store_dwordx4 v[164:167], v1, s[28:31], s63 offen offset:1024 sc1
    s_branch L_back5
L_def1:
    s_add_u32 s63, s6, 131072
    v_cvt_pk_bf16_f32 v112, v112, v113
    v_cvt_pk_bf16_f32 v113, v114, v115
    v_cvt_pk_bf16_f32 v114, v116, v117
    v_cvt_pk_bf16_f32 v115, v118, v119
    v_cvt_pk_bf16_f32 v116, v120, v121
    v_cvt_pk_bf16_f32 v117, v122, v123
    v_cvt_pk_bf16_f32 v118, v124, v125
    v_cvt_pk_bf16_f32 v119, v126, v127
    buffer_store_dwordx4 v[112:115], v176, s[28:31], s6 offen offset:0 sc1
    buffer_store_dwordx4 v[116:119], v176, s[28:31], s63 offen offset:0 sc1
    v_cvt_pk_bf16_f32 v128, v128, v129
    v_cvt_pk_bf16_f32 v129, v130, v131
    v_cvt_pk_bf16_f32 v130, v132, v133
    v_cvt_pk_bf16_f32 v131, v134, v135
    v_cvt_pk_bf16_f32 v132, v136, v137
    v_cvt_pk_bf16_f32 v133, v138, v139
    v_cvt_pk_bf16_f32 v134, v140, v141
    v_cvt_pk_bf16_f32 v135, v142, v143
    buffer_store_dwordx4 v[128:131], v177, s[28:31], s6 offen offset:1024 sc1
    buffer_store_dwordx4 v[132:135], v177, s[28:31], s6 offen offset:1536 sc1
    v_cvt_pk_bf16_f32 v144, v144, v145
    v_cvt_pk_bf16_f32 v145, v146, v147
    v_cvt_pk_bf16_f32 v146, v148, v149
    v_cvt_pk_bf16_f32 v147, v150, v151
    v_cvt_pk_bf16_f32 v148, v152, v153
    v_cvt_pk_bf16_f32 v149, v154, v155
    v_cvt_pk_bf16_f32 v150, v156, v157
    v_cvt_pk_bf16_f32 v151, v158, v159
    buffer_store_dwordx4 v[144:147], v176, s[28:31], s6 offen offset:2048 sc1
    buffer_store_dwordx4 v[148:151], v176, s[28:31], s63 offen offset:2048 sc1
    v_cvt_pk_bf16_f32 v160, v160, v161
    v_cvt_pk_bf16_f32 v161, v162, v163
    v_cvt_pk_bf16_f32 v162, v164, v165
    v_cvt_pk_bf16_f32 v163, v166, v167
    v_cvt_pk_bf16_f32 v164, v168, v169
    v_cvt_pk_bf16_f32 v165, v170, v171
    v_cvt_pk_bf16_f32 v166, v172, v173
    v_cvt_pk_bf16_f32 v167, v174, v175
    buffer_store_dwordx4 v[160:163], v177, s[28:31], s6 offen offset:3072 sc1
    buffer_store_dwordx4 v[164:167], v177, s[28:31], s6 offen offset:3584 sc1
    s_branch L_back5
L_hook0:
    s_cmp_lt_u32 s52, 2
    s_cbranch_scc1 L_h0a
    s_cmp_lt_u32 s52, 4
    s_cbranch_scc1 L_h0b
    s_waitcnt vmcnt(0)
L_h0b:
    s_waitcnt vmcnt(10)
    s_barrier
    s_branch L_back7
L_h0a:
    s_waitcnt vmcnt(6)
    s_barrier
    s_branch L_back7
L_hookp:
    s_cmp_eq_u32 s52, 4
    s_cbranch_scc0 L_back9
    v_lshlrev_b32 v6, 10, v0
    buffer_load_dword v8, v6, s[16:19], s75 offen
    buffer_load_dword v9, v6, s[12:15], s75 offen
    s_branch L_back9
L_hooks2:
    s_cmp_ge_u32 s52, 4
    s_cbranch_scc1 L_back13
    s_waitcnt vmcnt(0)
    v_mov_b32 v6, 0
    v_mov_b32 v7, s55
    s_mov_b64 exec, 1
    buffer_store_dword v7, v6, s[28:31], s37 offen sc1
    s_mov_b64 exec, -1
    s_branch L_back13
L_hooks3:
    s_waitcnt vmcnt(0)
    v_mov_b32 v6, 0
    v_mov_b32 v7, s55
    s_mov_b64 exec, 1
    buffer_store_dword v7, v6, s[28:31], s38 offen sc1
    s_mov_b64 exec, -1
    s_branch L_back13
L_hook1:
    s_lshl_b32 s60, s54, 9
    s_add_u32 s60, s60, 13639680
    v_and_b32 v6, 31, v0
    v_lshlrev_b32 v6, 4, v6
    buffer_load_dwordx4 v[12:15], v6, s[28:31], s60 offen sc1
    s_branch L_back23
L_hook2:
    s_lshl_b32 s60, s54, 9
    s_add_u32 s60, s60, 13639680
    s_waitcnt vmcnt(0)
    v_cmp_ne_u32 vcc, s55, v12
    v_cmp_ne_u32 s[70:71], s55, v13
    s_or_b64 vcc, vcc, s[70:71]
    v_cmp_ne_u32 s[70:71], s55, v14
    v_cmp_ne_u32 s[72:73], s55, v15
    s_or_b64 vcc, vcc, s[70:71]
    s_or_b64 vcc, vcc, s[72:73]
    s_cbranch_vccz L_ok_22
    v_and_b32 v6, 31, v0
    v_lshlrev_b32 v6, 4, v6
    s_mov_b32 s78, 300000
L_spin_21:
    buffer_load_dwordx4 v[12:15], v6, s[28:31], s60 offen sc1
    s_waitcnt vmcnt(0)
    v_cmp_ne_u32 vcc, s55, v12
    v_cmp_ne_u32 s[70:71], s55, v13
    s_or_b64 vcc, vcc, s[70:71]
    v_cmp_ne_u32 s[70:71], s55, v14
    v_cmp_ne_u32 s[72:73], s55, v15
    s_or_b64 vcc, vcc, s[70:71]
    s_or_b64 vcc, vcc, s[72:73]
    s_cbranch_vccz L_ok_22
    s_sub_u32 s78, s78, 1
    s_cmp_lg_u32 s78, 0
    s_cbranch_scc1 L_spin_21
L_ok_22:
    s_add_u32 s20, s50, s40
    s_addc_u32 s21, s51, 0
    s_mov_b32 s22, 131072
    s_mov_b32 s23, 0x00020000
    buffer_load_dwordx4 a[8:11], v1, s[28:31], s39 offen sc1
    buffer_load_dwordx4 a[12:15], v1, s[28:31], s39 offen offset:1024 sc1
    buffer_load_dwordx4 a[40:43], v1, s[20:23], s32 offen sc1
    s_lshl_b32 s61, s52, 12
    s_add_u32 s61, s61, 131072
    s_mov_b32 m0, s61
    s_nop 0
    buffer_load_dwordx4 v1, s[20:23], s41 offen offset:0 sc1 lds
    buffer_load_dwordx4 v1, s[20:23], s41 offen offset:1024 sc1 lds
    buffer_load_dwordx4 v1, s[20:23], s41 offen offset:2048 sc1 lds
    buffer_load_dwordx4 v1, s[20:23], s41 offen offset:3072 sc1 lds
    s_branch L_back25
L_hook3:
    v_add_u32 v2, s32, v1
    v_add_u32 v3, s32, v196
    ds_write_b128 v197, v[154:157]
    ds_write_b128 v197, v[158:161] offset:1024
    ds_write_b64 v198, v[162:163] offset:2048
    s_waitcnt vmcnt(0) lgkmcnt(0)
    s_barrier
    s_cmp_eq_u32 s76, 0
    s_cbranch_scc0 L_back7
    v_xor_b32 v6, 0x10000, v197
    v_xor_b32 v7, 0x10000, v198
    ds_read_b64 v[172:173], v7 offset:2048
    ds_read_b128 v[164:167], v6 offset:0
    ds_read_b128 v[168:171], v6 offset:1024
    s_waitcnt lgkmcnt(2)
    v_min_f32 v6, v153, v173
    v_sub_f32 v8, v6, v153
    v_sub_f32 v9, v6, v173
    v_max_f32 v8, 0xc3960000, v8
    v_max_f32 v9, 0xc3960000, v9
    v_cvt_i32_f32 v8, v8
    v_cvt_i32_f32 v9, v9
    v_ldexp_f32 v152, v152, v8
    v_ldexp_f32 v172, v172, v9
    v_add_f32 v6, v152, v172
    v_rcp_f32 v6, v6
    s_nop 0
    v_ldexp_f32 v8, v6, v8
    v_ldexp_f32 v9, v6, v9
    s_waitcnt lgkmcnt(0)
    v_pk_mul_f32 v[144:145], v[144:145], v[8:9] op_sel:[0,0] op_sel_hi:[1,0]
    v_pk_mul_f32 v[146:147], v[146:147], v[8:9] op_sel:[0,0] op_sel_hi:[1,0]
    v_pk_mul_f32 v[148:149], v[148:149], v[8:9] op_sel:[0,0] op_sel_hi:[1,0]
    v_pk_mul_f32 v[150:151], v[150:151], v[8:9] op_sel:[0,0] op_sel_hi:[1,0]
    v_pk_fma_f32 v[144:145], v[164:165], v[8:9], v[144:145] op_sel:[0,1,0] op_sel_hi:[1,1,1]
    v_pk_fma_f32 v[146:147], v[166:167], v[8:9], v[146:147] op_sel:[0,1,0] op_sel_hi:[1,1,1]
    v_pk_fma_f32 v[148:149], v[168:169], v[8:9], v[148:149] op_sel:[0,1,0] op_sel_hi:[1,1,1]
    v_pk_fma_f32 v[150:151], v[170:171], v[8:9], v[150:151] op_sel:[0,1,0] op_sel_hi:[1,1,1]
    v_cvt_pk_bf16_f32 v144, v144, v145
    v_cvt_pk_bf16_f32 v145, v146, v147
    v_cvt_pk_bf16_f32 v146, v148, v149
    v_cvt_pk_bf16_f32 v147, v150, v151
    buffer_store_dwordx4 v[144:147], v1, s[28:31], s35 offen sc1
    s_branch L_back7
L_hook3a:
    s_cmp_eq_u32 s76, 0
    s_cbranch_scc1 L_back9
    v_xor_b32 v6, 0x10000, v197
    v_xor_b32 v7, 0x10000, v198
    ds_read_b64 v[172:173], v7 offset:2048
    ds_read_b128 v[164:167], v6 offset:0
    ds_read_b128 v[168:171], v6 offset:1024
    s_waitcnt lgkmcnt(2)
    v_min_f32 v6, v153, v173
    v_sub_f32 v8, v6, v153
    v_sub_f32 v9, v6, v173
    v_max_f32 v8, 0xc3960000, v8
    v_max_f32 v9, 0xc3960000, v9
    v_cvt_i32_f32 v8, v8
    v_cvt_i32_f32 v9, v9
    v_ldexp_f32 v152, v152, v8
    v_ldexp_f32 v172, v172, v9
    v_add_f32 v6, v152, v172
    v_rcp_f32 v6, v6
    s_nop 0
    v_ldexp_f32 v8, v6, v8
    v_ldexp_f32 v9, v6, v9
    s_waitcnt lgkmcnt(0)
    v_pk_mul_f32 v[144:145], v[144:145], v[8:9] op_sel:[0,0] op_sel_hi:[1,0]
    v_pk_mul_f32 v[146:147], v[146:147], v[8:9] op_sel:[0,0] op_sel_hi:[1,0]
    v_pk_mul_f32 v[148:149], v[148:149], v[8:9] op_sel:[0,0] op_sel_hi:[1,0]
    v_pk_mul_f32 v[150:151], v[150:151], v[8:9] op_sel:[0,0] op_sel_hi:[1,0]
    v_pk_fma_f32 v[144:145], v[164:165], v[8:9], v[144:145] op_sel:[0,1,0] op_sel_hi:[1,1,1]
    v_pk_fma_f32 v[146:147], v[166:167], v[8:9], v[146:147] op_sel:[0,1,0] op_sel_hi:[1,1,1]
    v_pk_fma_f32 v[148:149], v[168:169], v[8:9], v[148:149] op_sel:[0,1,0] op_sel_hi:[1,1,1]
    v_pk_fma_f32 v[150:151], v[170:171], v[8:9], v[150:151] op_sel:[0,1,0] op_sel_hi:[1,1,1]
    v_cvt_pk_bf16_f32 v144, v144, v145
    v_cvt_pk_bf16_f32 v145, v146, v147
    v_cvt_pk_bf16_f32 v146, v148, v149
    v_cvt_pk_bf16_f32 v147, v150, v151
    buffer_store_dwordx4 v[144:147], v1, s[28:31], s35 offen sc1
    s_branch L_back9
L_hookx:
    s_cmp_eq_u32 s76, 0
    s_cbranch_scc1 L_back30
    s_barrier
    s_branch L_back30
L_hook6:
    s_waitcnt vmcnt(0)
    s_barrier
    v_lshlrev_b32 v6, 2, v0
    buffer_load_dword v10, v6, s[28:31], s79 offen sc1
    s_branch L_back23
L_hook5:
    s_waitcnt vmcnt(8)
    v_cmp_ne_u32 vcc, s55, v10
    s_cbranch_vccz L_ok_24
    v_lshlrev_b32 v6, 2, v0
    s_mov_b32 s78, 300000
L_spin_23:
    buffer_load_dword v10, v6, s[28:31], s79 offen sc1
    s_waitcnt vmcnt(0)
    v_cmp_ne_u32 vcc, s55, v10
    s_cbranch_vccz L_ok_24
    s_sub_u32 s78, s78, 1
    s_cmp_lg_u32 s78, 0
    s_cbranch_scc1 L_spin_23
L_ok_24:
    s_add_u32 s62, s4, 32768
    buffer_load_dwordx4 v[112:115], v1, s[28:31], s62 offen offset:0 sc1
    buffer_load_dwordx4 v[116:119], v1, s[28:31], s62 offen offset:1024 sc1
    buffer_load_dwordx4 v[120:123], v1, s[28:31], s62 offen offset:2048 sc1
    buffer_load_dwordx4 v[124:127], v1, s[28:31], s62 offen offset:3072 sc1
    s_add_u32 s62, s62, 4096
    buffer_load_dwordx4 v[128:131], v1, s[28:31], s62 offen offset:0 sc1
    buffer_load_dwordx4 v[132:135], v1, s[28:31], s62 offen offset:1024 sc1
    buffer_load_dwordx4 v[136:139], v1, s[28:31], s62 offen offset:2048 sc1
    buffer_load_dwordx4 v[140:143], v1, s[28:31], s62 offen offset:3072 sc1
    v_and_b32 v6, 31, v0
    v_lshlrev_b32 v6, 2, v6
    buffer_load_dword v5, v6, s[28:31], s5 offen sc1
    s_branch L_back25
L_fallback:
    s_cmp_eq_u32 s59, 0
    s_cselect_b32 s60, 8388608, s40
    s_add_u32 s60, s60, s32
    s_mov_b32 s61, s60
    s_mov_b32 s56, 0
    v_mov_b32 v12, 0xff800000
    v_mov_b32 v13, 0xff800000
    s_waitcnt vmcnt(0) lgkmcnt(0)
L_fb_max:
    buffer_load_dwordx4 v[144:147], v1, s[28:31], s61 offen offset:0 sc1
    buffer_load_dwordx4 v[148:151], v1, s[28:31], s61 offen offset:2048 sc1
    s_add_u32 s61, s61, 4096
    buffer_load_dwordx4 v[152:155], v1, s[28:31], s61 offen offset:0 sc1
    buffer_load_dwordx4 v[156:159], v1, s[28:31], s61 offen offset:2048 sc1
    s_add_u32 s61, s61, 4096
    buffer_load_dwordx4 v[160:163], v1, s[28:31], s61 offen offset:0 sc1
    buffer_load_dwordx4 v[164:167], v1, s[28:31], s61 offen offset:2048 sc1
    s_add_u32 s61, s61, 4096
    buffer_load_dwordx4 v[168:171], v1, s[28:31], s61 offen offset:0 sc1
    buffer_load_dwordx4 v[172:175], v1, s[28:31], s61 offen offset:2048 sc1
    s_waitcnt vmcnt(7)
    v_mfma_f32_32x32x16_bf16 v[16:31], v[144:147], a[0:3], 0
    v_mfma_f32_32x32x16_bf16 v[32:47], v[144:147], a[4:7], 0
    s_nop 11
    v_max3_f32 v2, v16, v17, v18
    v_max3_f32 v6, v19, v20, v21
    v_max3_f32 v8, v22, v23, v24
    v_max3_f32 v9, v25, v26, v27
    v_max3_f32 v2, v2, v28, v29
    v_max3_f32 v6, v6, v30, v31
    v_max3_f32 v2, v2, v8, v9
    v_max_f32 v2, v2, v6
    v_max_f32 v12, v12, v2
    v_max3_f32 v2, v32, v33, v34
    v_max3_f32 v6, v35, v36, v37
    v_max3_f32 v8, v38, v39, v40
    v_max3_f32 v9, v41, v42, v43
    v_max3_f32 v2, v2, v44, v45
    v_max3_f32 v6, v6, v46, v47
    v_max3_f32 v2, v2, v8, v9
    v_max_f32 v2, v2, v6
    v_max_f32 v13, v13, v2
    s_waitcnt vmcnt(6)
    v_mfma_f32_32x32x16_bf16 v[16:31], v[148:151], a[0:3], 0
    v_mfma_f32_32x32x16_bf16 v[32:47], v[148:151], a[4:7], 0
    s_nop 11
    v_max3_f32 v2, v16, v17, v18
    v_max3_f32 v6, v19, v20, v21
    v_max3_f32 v8, v22, v23, v24
    v_max3_f32 v9, v25, v26, v27
    v_max3_f32 v2, v2, v28, v29
    v_max3_f32 v6, v6, v30, v31
    v_max3_f32 v2, v2, v8, v9
    v_max_f32 v2, v2, v6
    v_max_f32 v12, v12, v2
    v_max3_f32 v2, v32, v33, v34
    v_max3_f32 v6, v35, v36, v37
    v_max3_f32 v8, v38, v39, v40
    v_max3_f32 v9, v41, v42, v43
    v_max3_f32 v2, v2, v44, v45
    v_max3_f32 v6, v6, v46, v47
    v_max3_f32 v2, v2, v8, v9
    v_max_f32 v2, v2, v6
    v_max_f32 v13, v13, v2
    s_waitcnt vmcnt(5)
    v_mfma_f32_32x32x16_bf16 v[16:31], v[152:155], a[0:3], 0
    v_mfma_f32_32x32x16_bf16 v[32:47], v[152:155], a[4:7], 0
    s_nop 11
    v_max3_f32 v2, v16, v17, v18
    v_max3_f32 v6, v19, v20, v21
    v_max3_f32 v8, v22, v23, v24
    v_max3_f32 v9, v25, v26, v27
    v_max3_f32 v2, v2, v28, v29
    v_max3_f32 v6, v6, v30, v31
    v_max3_f32 v2, v2, v8, v9
    v_max_f32 v2, v2, v6
    v_max_f32 v12, v12, v2
    v_max3_f32 v2, v32, v33, v34
    v_max3_f32 v6, v35, v36, v37
    v_max3_f32 v8, v38, v39, v40
    v_max3_f32 v9, v41, v42, v43
    v_max3_f32 v2, v2, v44, v45
    v_max3_f32 v6, v6, v46, v47
    v_max3_f32 v2, v2, v8, v9
    v_max_f32 v2, v2, v6
    v_max_f32 v13, v13, v2
    s_waitcnt vmcnt(4)
    v_mfma_f32_32x32x16_bf16 v[16:31], v[156:159], a[0:3], 0
    v_mfma_f32_32x32x16_bf16 v[32:47], v[156:159], a[4:7], 0
    s_nop 11
    v_max3_f32 v2, v16, v17, v18
    v_max3_f32 v6, v19, v20, v21
    v_max3_f32 v8, v22, v23, v24
    v_max3_f32 v9, v25, v26, v27
    v_max3_f32 v2, v2, v28, v29
    v_max3_f32 v6, v6, v30, v31
    v_max3_f32 v2, v2, v8, v9
    v_max_f32 v2, v2, v6
    v_max_f32 v12, v12, v2
    v_max3_f32 v2, v32, v33, v34
    v_max3_f32 v6, v35, v36, v37
    v_max3_f32 v8, v38, v39, v40
    v_max3_f32 v9, v41, v42, v43
    v_max3_f32 v2, v2, v44, v45
    v_max3_f32 v6, v6, v46, v47
    v_max3_f32 v2, v2, v8, v9
    v_max_f32 v2, v2, v6
    v_max_f32 v13, v13, v2
    s_waitcnt vmcnt(3)
    v_mfma_f32_32x32x16_bf16 v[16:31], v[160:163], a[0:3], 0
    v_mfma_f32_32x32x16_bf16 v[32:47], v[160:163], a[4:7], 0
    s_nop 11
    v_max3_f32 v2, v16, v17, v18
    v_max3_f32 v6, v19, v20, v21
    v_max3_f32 v8, v22, v23, v24
    v_max3_f32 v9, v25, v26, v27
    v_max3_f32 v2, v2, v28, v29
    v_max3_f32 v6, v6, v30, v31
    v_max3_f32 v2, v2, v8, v9
    v_max_f32 v2, v2, v6
    v_max_f32 v12, v12, v2
    v_max3_f32 v2, v32, v33, v34
    v_max3_f32 v6, v35, v36, v37
    v_max3_f32 v8, v38, v39, v40
    v_max3_f32 v9, v41, v42, v43
    v_max3_f32 v2, v2, v44, v45
    v_max3_f32 v6, v6, v46, v47
    v_max3_f32 v2, v2, v8, v9
    v_max_f32 v2, v2, v6
    v_max_f32 v13, v13, v2
    s_waitcnt vmcnt(2)
    v_mfma_f32_32x32x16_bf16 v[16:31], v[164:167], a[0:3], 0
    v_mfma_f32_32x32x16_bf16 v[32:47], v[164:167], a[4:7], 0
    s_nop 11
    v_max3_f32 v2, v16, v17, v18
    v_max3_f32 v6, v19, v20, v21
    v_max3_f32 v8, v22, v23, v24
    v_max3_f32 v9, v25, v26, v27
    v_max3_f32 v2, v2, v28, v29
    v_max3_f32 v6, v6, v30, v31
    v_max3_f32 v2, v2, v8, v9
    v_max_f32 v2, v2, v6
    v_max_f32 v12, v12, v2
    v_max3_f32 v2, v32, v33, v34
    v_max3_f32 v6, v35, v36, v37
    v_max3_f32 v8, v38, v39, v40
    v_max3_f32 v9, v41, v42, v43
    v_max3_f32 v2, v2, v44, v45
    v_max3_f32 v6, v6, v46, v47
    v_max3_f32 v2, v2, v8, v9
    v_max_f32 v2, v2, v6
    v_max_f32 v13, v13, v2
    s_waitcnt vmcnt(1)
    v_mfma_f32_32x32x16_bf16 v[16:31], v[168:171], a[0:3], 0
    v_mfma_f32_32x32x16_bf16 v[32:47], v[168:171], a[4:7], 0
    s_nop 11
    v_max3_f32 v2, v16, v17, v18
    v_max3_f32 v6, v19, v20, v21
    v_max3_f32 v8, v22, v23, v24
    v_max3_f32 v9, v25, v26, v27
    v_max3_f32 v2, v2, v28, v29
    v_max3_f32 v6, v6, v30, v31
    v_max3_f32 v2, v2, v8, v9
    v_max_f32 v2, v2, v6
    v_max_f32 v12, v12, v2
    v_max3_f32 v2, v32, v33, v34
    v_max3_f32 v6, v35, v36, v37
    v_max3_f32 v8, v38, v39, v40
    v_max3_f32 v9, v41, v42, v43
    v_max3_f32 v2, v2, v44, v45
    v_max3_f32 v6, v6, v46, v47
    v_max3_f32 v2, v2, v8, v9
    v_max_f32 v2, v2, v6
    v_max_f32 v13, v13, v2
    s_waitcnt vmcnt(0)
    v_mfma_f32_32x32x16_bf16 v[16:31], v[172:175], a[0:3], 0
    v_mfma_f32_32x32x16_bf16 v[32:47], v[172:175], a[4:7], 0
    s_nop 11
    v_max3_f32 v2, v16, v17, v18
    v_max3_f32 v6, v19, v20, v21
    v_max3_f32 v8, v22, v23, v24
    v_max3_f32 v9, v25, v26, v27
    v_max3_f32 v2, v2, v28, v29
    v_max3_f32 v6, v6, v30, v31
    v_max3_f32 v2, v2, v8, v9
    v_max_f32 v2, v2, v6
    v_max_f32 v12, v12, v2
    v_max3_f32 v2, v32, v33, v34
    v_max3_f32 v6, v35, v36, v37
    v_max3_f32 v8, v38, v39, v40
    v_max3_f32 v9, v41, v42, v43
    v_max3_f32 v2, v2, v44, v45
    v_max3_f32 v6, v6, v46, v47
    v_max3_f32 v2, v2, v8, v9
    v_max_f32 v2, v2, v6
    v_max_f32 v13, v13, v2
    s_add_u32 s61, s61, 4096
    s_add_u32 s56, s56, 1
    s_cmp_lt_u32 s56, 4
    s_cbranch_scc1 L_fb_max
    v_mov_b32 v6, v12
    v_mov_b32 v8, v13
    s_nop 0
    v_permlane32_swap_b32 v6, v12
    v_permlane32_swap_b32 v8, v13
    s_nop 0
    v_max_f32 v6, v6, v12
    v_max_f32 v8, v8, v13
    v_ceil_f32 v6, v6
    v_ceil_f32 v8, v8
    v_sub_f32 v16, 0, v6
    v_sub_f32 v17, 0, v6
    v_sub_f32 v32, 0, v8
    v_sub_f32 v33, 0, v8
    v_pk_mov_b32 v[18:19], v[16:17], v[16:17]
    v_pk_mov_b32 v[20:21], v[16:17], v[16:17]
    v_pk_mov_b32 v[22:23], v[16:17], v[16:17]
    v_pk_mov_b32 v[24:25], v[16:17], v[16:17]
    v_pk_mov_b32 v[26:27], v[16:17], v[16:17]
    v_pk_mov_b32 v[28:29], v[16:17], v[16:17]
    v_pk_mov_b32 v[30:31], v[16:17], v[16:17]
    v_pk_mov_b32 v[34:35], v[32:33], v[32:33]
    v_pk_mov_b32 v[36:37], v[32:33], v[32:33]
    v_pk_mov_b32 v[38:39], v[32:33], v[32:33]
    v_pk_mov_b32 v[40:41], v[32:33], v[32:33]
    v_pk_mov_b32 v[42:43], v[32:33], v[32:33]
    v_pk_mov_b32 v[44:45], v[32:33], v[32:33]
    v_pk_mov_b32 v[46:47], v[32:33], v[32:33]
    v_pk_mov_b32 v[80:81], 0, 0
    v_pk_mov_b32 v[82:83], 0, 0
    v_pk_mov_b32 v[84:85], 0, 0
    v_pk_mov_b32 v[86:87], 0, 0
    v_pk_mov_b32 v[88:89], 0, 0
    v_pk_mov_b32 v[90:91], 0, 0
    v_pk_mov_b32 v[92:93], 0, 0
    v_pk_mov_b32 v[94:95], 0, 0
    v_pk_mov_b32 v[96:97], 0, 0
    v_pk_mov_b32 v[98:99], 0, 0
    v_pk_mov_b32 v[100:101], 0, 0
    v_pk_mov_b32 v[102:103], 0, 0
    v_pk_mov_b32 v[104:105], 0, 0
    v_pk_mov_b32 v[106:107], 0, 0
    v_pk_mov_b32 v[108:109], 0, 0
    v_pk_mov_b32 v[110:111], 0, 0
    v_accvgpr_read_b32 v160, a20
    v_accvgpr_read_b32 v161, a20
    v_accvgpr_read_b32 v162, a20
    v_accvgpr_read_b32 v163, a20
    v_accvgpr_read_b32 v164, a20
    v_accvgpr_read_b32 v165, a20
    v_accvgpr_read_b32 v166, a20
    v_accvgpr_read_b32 v167, a20
    v_accvgpr_read_b32 v168, a20
    v_accvgpr_read_b32 v169, a20
    v_accvgpr_read_b32 v170, a20
    v_accvgpr_read_b32 v171, a20
    v_accvgpr_read_b32 v172, a20
    v_accvgpr_read_b32 v173, a20
    v_accvgpr_read_b32 v174, a20
    v_accvgpr_read_b32 v175, a20
    buffer_load_dwordx4 v[144:147], v1, s[28:31], s60 offen sc1
    s_mov_b64 exec, s[68:69]
    buffer_load_dwordx4 a[20:23], v196, s[28:31], s60 offen offset:1024 sc1
    buffer_load_dwordx4 a[24:27], v196, s[28:31], s60 offen offset:1536 sc1
    s_mov_b64 exec, -1
    s_add_u32 s60, s60, 2048
    buffer_load_dwordx4 v[148:151], v1, s[28:31], s60 offen sc1
    s_mov_b64 exec, s[68:69]
    buffer_load_dwordx4 a[32:35], v196, s[28:31], s60 offen offset:1024 sc1
    buffer_load_dwordx4 a[36:39], v196, s[28:31], s60 offen offset:1536 sc1
    s_mov_b64 exec, -1
    s_add_u32 s60, s60, 2048
    buffer_load_dwordx4 v[152:155], v1, s[28:31], s60 offen sc1
    s_mov_b64 exec, s[68:69]
    buffer_load_dwordx4 v[160:163], v196, s[28:31], s60 offen offset:1024 sc1
    buffer_load_dwordx4 v[164:167], v196, s[28:31], s60 offen offset:1536 sc1
    s_mov_b64 exec, -1
    s_add_u32 s60, s60, 2048
    s_mov_b32 s56, 0
L_fb_sum:
    buffer_load_dwordx4 v[156:159], v1, s[28:31], s60 offen sc1
    s_mov_b64 exec, s[68:69]
    buffer_load_dwordx4 v[168:171], v196, s[28:31], s60 offen offset:1024 sc1
    buffer_load_dwordx4 v[172:175], v196, s[28:31], s60 offen offset:1536 sc1
    s_mov_b64 exec, -1
    s_add_u32 s60, s60, 2048
    s_waitcnt vmcnt(9)
    v_mfma_f32_32x32x16_bf16 v[48:63], v[144:147], a[0:3], v[16:31]
    v_mfma_f32_32x32x16_bf16 v[64:79], v[144:147], a[4:7], v[32:47]
    s_nop 11
    v_exp_f32 v48, v48
    v_exp_f32 v49, v49
    v_exp_f32 v50, v50
    v_exp_f32 v51, v51
    v_exp_f32 v52, v52
    v_exp_f32 v53, v53
    v_exp_f32 v54, v54
    v_exp_f32 v55, v55
    v_exp_f32 v56, v56
    v_exp_f32 v57, v57
    v_exp_f32 v58, v58
    v_exp_f32 v59, v59
    v_exp_f32 v60, v60
    v_exp_f32 v61, v61
    v_exp_f32 v62, v62
    v_exp_f32 v63, v63
    v_exp_f32 v64, v64
    v_exp_f32 v65, v65
    v_exp_f32 v66, v66
    v_exp_f32 v67, v67
    v_exp_f32 v68, v68
    v_exp_f32 v69, v69
    v_exp_f32 v70, v70
    v_exp_f32 v71, v71
    v_exp_f32 v72, v72
    v_exp_f32 v73, v73
    v_exp_f32 v74, v74
    v_exp_f32 v75, v75
    v_exp_f32 v76, v76
    v_exp_f32 v77, v77
    v_exp_f32 v78, v78
    v_exp_f32 v79, v79
    s_nop 1
    v_smfmac_f32_32x32x32_bf16 v[80:95], a[20:23], v[48:55], v4
    v_smfmac_f32_32x32x32_bf16 v[80:95], a[24:27], v[56:63], v4
    v_smfmac_f32_32x32x32_bf16 v[96:111], a[20:23], v[64:71], v4
    v_smfmac_f32_32x32x32_bf16 v[96:111], a[24:27], v[72:79], v4
    buffer_load_dwordx4 v[144:147], v1, s[28:31], s60 offen sc1
    s_mov_b64 exec, s[68:69]
    buffer_load_dwordx4 a[20:23], v196, s[28:31], s60 offen offset:1024 sc1
    buffer_load_dwordx4 a[24:27], v196, s[28:31], s60 offen offset:1536 sc1
    s_mov_b64 exec, -1
    s_add_u32 s60, s60, 2048
    s_waitcnt vmcnt(9)
    v_mfma_f32_32x32x16_bf16 v[48:63], v[148:151], a[0:3], v[16:31]
    v_mfma_f32_32x32x16_bf16 v[64:79], v[148:151], a[4:7], v[32:47]
    s_nop 11
    v_exp_f32 v48, v48
    v_exp_f32 v49, v49
    v_exp_f32 v50, v50
    v_exp_f32 v51, v51
    v_exp_f32 v52, v52
    v_exp_f32 v53, v53
    v_exp_f32 v54, v54
    v_exp_f32 v55, v55
    v_exp_f32 v56, v56
    v_exp_f32 v57, v57
    v_exp_f32 v58, v58
    v_exp_f32 v59, v59
    v_exp_f32 v60, v60
    v_exp_f32 v61, v61
    v_exp_f32 v62, v62
    v_exp_f32 v63, v63
    v_exp_f32 v64, v64
    v_exp_f32 v65, v65
    v_exp_f32 v66, v66
    v_exp_f32 v67, v67
    v_exp_f32 v68, v68
    v_exp_f32 v69, v69
    v_exp_f32 v70, v70
    v_exp_f32 v71, v71
    v_exp_f32 v72, v72
    v_exp_f32 v73, v73
    v_exp_f32 v74, v74
    v_exp_f32 v75, v75
    v_exp_f32 v76, v76
    v_exp_f32 v77, v77
    v_exp_f32 v78, v78
    v_exp_f32 v79, v79
    s_nop 1
    v_smfmac_f32_32x32x32_bf16 v[80:95], a[32:35], v[48:55], v4
    v_smfmac_f32_32x32x32_bf16 v[80:95], a[36:39], v[56:63], v4
    v_smfmac_f32_32x32x32_bf16 v[96:111], a[32:35], v[64:71], v4
    v_smfmac_f32_32x32x32_bf16 v[96:111], a[36:39], v[72:79], v4
    buffer_load_dwordx4 v[148:151], v1, s[28:31], s60 offen sc1
    s_mov_b64 exec, s[68:69]
    buffer_load_dwordx4 a[32:35], v196, s[28:31], s60 offen offset:1024 sc1
    buffer_load_dwordx4 a[36:39], v196, s[28:31], s60 offen offset:1536 sc1
    s_mov_b64 exec, -1
    s_add_u32 s60, s60, 2048
    s_waitcnt vmcnt(9)
    v_mfma_f32_32x32x16_bf16 v[48:63], v[152:155], a[0:3], v[16:31]
    v_mfma_f32_32x32x16_bf16 v[64:79], v[152:155], a[4:7], v[32:47]
    s_nop 11
    v_exp_f32 v48, v48
    v_exp_f32 v49, v49
    v_exp_f32 v50, v50
    v_exp_f32 v51, v51
    v_exp_f32 v52, v52
    v_exp_f32 v53, v53
    v_exp_f32 v54, v54
    v_exp_f32 v55, v55
    v_exp_f32 v56, v56
    v_exp_f32 v57, v57
    v_exp_f32 v58, v58
    v_exp_f32 v59, v59
    v_exp_f32 v60, v60
    v_exp_f32 v61, v61
    v_exp_f32 v62, v62
    v_exp_f32 v63, v63
    v_exp_f32 v64, v64
    v_exp_f32 v65, v65
    v_exp_f32 v66, v66
    v_exp_f32 v67, v67
    v_exp_f32 v68, v68
    v_exp_f32 v69, v69
    v_exp_f32 v70, v70
    v_exp_f32 v71, v71
    v_exp_f32 v72, v72
    v_exp_f32 v73, v73
    v_exp_f32 v74, v74
    v_exp_f32 v75, v75
    v_exp_f32 v76, v76
    v_exp_f32 v77, v77
    v_exp_f32 v78, v78
    v_exp_f32 v79, v79
    s_nop 1
    v_smfmac_f32_32x32x32_bf16 v[80:95], v[160:163], v[48:55], v4
    v_smfmac_f32_32x32x32_bf16 v[80:95], v[164:167], v[56:63], v4
    v_smfmac_f32_32x32x32_bf16 v[96:111], v[160:163], v[64:71], v4
    v_smfmac_f32_32x32x32_bf16 v[96:111], v[164:167], v[72:79], v4
    buffer_load_dwordx4 v[152:155], v1, s[28:31], s60 offen sc1
    s_mov_b64 exec, s[68:69]
    buffer_load_dwordx4 v[160:163], v196, s[28:31], s60 offen offset:1024 sc1
    buffer_load_dwordx4 v[164:167], v196, s[28:31], s60 offen offset:1536 sc1
    s_mov_b64 exec, -1
    s_add_u32 s60, s60, 2048
    s_waitcnt vmcnt(9)
    v_mfma_f32_32x32x16_bf16 v[48:63], v[156:159], a[0:3], v[16:31]
    v_mfma_f32_32x32x16_bf16 v[64:79], v[156:159], a[4:7], v[32:47]
    s_nop 11
    v_exp_f32 v48, v48
    v_exp_f32 v49, v49
    v_exp_f32 v50, v50
    v_exp_f32 v51, v51
    v_exp_f32 v52, v52
    v_exp_f32 v53, v53
    v_exp_f32 v54, v54
    v_exp_f32 v55, v55
    v_exp_f32 v56, v56
    v_exp_f32 v57, v57
    v_exp_f32 v58, v58
    v_exp_f32 v59, v59
    v_exp_f32 v60, v60
    v_exp_f32 v61, v61
    v_exp_f32 v62, v62
    v_exp_f32 v63, v63
    v_exp_f32 v64, v64
    v_exp_f32 v65, v65
    v_exp_f32 v66, v66
    v_exp_f32 v67, v67
    v_exp_f32 v68, v68
    v_exp_f32 v69, v69
    v_exp_f32 v70, v70
    v_exp_f32 v71, v71
    v_exp_f32 v72, v72
    v_exp_f32 v73, v73
    v_exp_f32 v74, v74
    v_exp_f32 v75, v75
    v_exp_f32 v76, v76
    v_exp_f32 v77, v77
    v_exp_f32 v78, v78
    v_exp_f32 v79, v79
    s_nop 1
    v_smfmac_f32_32x32x32_bf16 v[80:95], v[168:171], v[48:55], v4
    v_smfmac_f32_32x32x32_bf16 v[80:95], v[172:175], v[56:63], v4
    v_smfmac_f32_32x32x32_bf16 v[96:111], v[168:171], v[64:71], v4
    v_smfmac_f32_32x32x32_bf16 v[96:111], v[172:175], v[72:79], v4
    s_add_u32 s56, s56, 1
    s_cmp_lt_u32 s56, 8
    s_cbranch_scc1 L_fb_sum
    s_nop 13
    s_branch L_fin
L_done:
    s_endpgm
.section .rodata,"a"
.p2align 6
.amdhsa_kernel gated_mix__mha_block__grouped_kv_mqa__prompt_kernel
  .amdhsa_next_free_vgpr 244
  .amdhsa_next_free_sgpr 102
  .amdhsa_accum_offset 200
  .amdhsa_group_segment_fixed_size 0
  .amdhsa_kernarg_size 96
  .amdhsa_user_sgpr_count 2
  .amdhsa_user_sgpr_kernarg_segment_ptr 1
  .amdhsa_system_sgpr_workgroup_id_x 1
  .amdhsa_float_denorm_mode_32 0
.end_amdhsa_kernel
.text
```
